```python
import torch

def _softmax(x, axis=-1):
    return torch.softmax(x, dim=axis)
def _gelu(x):
    return torch.nn.functional.gelu(x, approximate="tanh")
def _silu(x):
    return torch.nn.functional.silu(x)
def _sigmoid(x):
    return torch.sigmoid(x)
def _layernorm(x, axis=-1, eps=1e-5):
    m = x.mean(dim=axis, keepdim=True)
    v = x.var(dim=axis, keepdim=True, unbiased=False)
    return (x - m) / torch.sqrt(v + eps)
def _scatter_add(tgt, idx, src, axis=0):
    return tgt.clone().index_add_(axis, idx, src)
def _segment_sum(src, seg, n):
    out = torch.zeros((n,) + src.shape[1:], dtype=src.dtype)
    return out.index_add_(0, seg, src)
def _pad(x, pw):
    flat = tuple(v for pair in reversed(pw) for v in pair)
    return torch.nn.functional.pad(x, flat)

kernel_name = 'gated_mix__grouped_kv_mqa__dense_activation_silu__prompt'

def setup_inputs():

    _w = (lambda a: (lambda t: t.to(torch.bfloat16) if t.is_floating_point() else t)(torch.as_tensor(a)))
    def _A_setup():
        B, S, D, H = 1, 2048, 512, 32
        Dh = D // H
        return {
            "x": _w((lambda *s: torch.randn(*s, dtype=torch.bfloat16) * 0.05)(B, S, D)),
            "wq": _w((lambda *s: torch.randn(*s, dtype=torch.bfloat16) * 0.8)(D, H * Dh)),
            "wk": _w((lambda *s: torch.randn(*s, dtype=torch.bfloat16) * 0.8)(D, Dh)),
            "wv": _w((lambda *s: torch.randn(*s, dtype=torch.bfloat16) * 0.05)(D, Dh)),
            "wo": _w((lambda *s: torch.randn(*s, dtype=torch.bfloat16) * 0.05)(H * Dh, D)),
        }
    _A_in = _A_setup()

    def _B_setup():
        B, S, D, F = 1, 2048, 512, 1376
        return {
            "x": _w((lambda *s: torch.randn(*s, dtype=torch.bfloat16) * 0.05)(B, S, D)),
            "w1": _w((lambda *s: torch.randn(*s, dtype=torch.bfloat16) * 3.2)(D, F) * (D ** -0.5)),
            "w2": _w((lambda *s: torch.randn(*s, dtype=torch.bfloat16) * 0.1)(F, D) * (F ** -0.5)),
        }
    _B_in = _B_setup()

    return {
        "A_x": _A_in["x"],
        "A_wq": _A_in["wq"],
        "A_wk": _A_in["wk"],
        "A_wv": _A_in["wv"],
        "A_wo": _A_in["wo"],
        "B_x": _B_in["x"],
        "B_w1": _B_in["w1"],
        "B_w2": _B_in["w2"],
        "gate_w": _w((lambda *s: torch.randn(*s, dtype=torch.bfloat16) * 0.05)(512) * 16.0),
    }

def reference(A_x, A_wq, A_wk, A_wv, A_wo, B_x, B_w1, B_w2, gate_w):
    def _A_ref(x, wq, wk, wv, wo):
        B, S, D = x.shape
        H = 32
        Dh = D // H
        q = (lambda x, *d: x.permute(*d))((x @ wq).reshape(B, S, H, Dh), 0, 2, 1, 3)
        k = x @ wk
        v = x @ wv
        scores = torch.einsum("bhqd,bkd->bhqk", q, k) * (Dh ** -0.5)
        p = _softmax(scores, axis=-1)
        o = torch.einsum("bhqk,bkd->bhqd", p, v)
        return (lambda x, *d: x.permute(*d))(o, 0, 2, 1, 3).reshape(B, S, H * Dh) @ wo

    def _B_ref(x, w1, w2):
        h = torch.einsum("bsd,df->bsf", x, w1)
        h = _silu(h)
        out = torch.einsum("bsf,fd->bsd", h, w2)
        return out

    x = A_x
    g = _sigmoid((x * gate_w).sum(-1, keepdims=True))
    a = _A_ref(x, A_wq, A_wk, A_wv, A_wo)
    b = _B_ref(x, B_w1, B_w2)
    return g * a + (1 - g) * b
```

```asm
; @launch grid=(256,1,1) block=(512,1,1) lds=163840
.amdgcn_target "amdgcn-amd-amdhsa--gfx950"
.text
.globl gated_mix__grouped_kv_mqa__dense_activation_silu__prompt_kernel
.p2align 8
.type gated_mix__grouped_kv_mqa__dense_activation_silu__prompt_kernel,@function
gated_mix__grouped_kv_mqa__dense_activation_silu__prompt_kernel:
    s_cmp_ge_u32 s2, 256
    s_cbranch_scc1 L_exit
    s_load_dwordx16 s[4:19], s[0:1], 0
    s_load_dwordx8 s[20:27], s[0:1], 64
    v_lshrrev_b32 v1, 6, v0
    v_and_b32 v0, 63, v0
    s_bfe_u32 s3, s2, 0x20001
    v_readfirstlane_b32 s28, v1
    s_bfe_u32 s31, s2, 0x20003
    s_lshl_b32 s29, s3, 2
    s_add_u32 s29, s29, s31
    s_lshl_b32 s31, s31, 1
    s_add_u32 s31, s31, s3
    s_lshr_b32 s30, s2, 5
    s_add_u32 s31, s31, s30
    s_and_b32 s3, s2, 1
    s_lshl_b32 s3, s3, 3
    s_add_u32 s30, s30, s3
    s_mov_b32 s97, 1048576
    s_and_b32 s48, s28, 3
    v_lshlrev_b32 v1, 4, v0
    s_cmp_ge_u32 s28, 4
    s_cbranch_scc1 L_cg
    v_lshrrev_b32 v10, 3, v0
    v_lshrrev_b32 v11, 4, v0
    v_and_b32 v12, 7, v0
    v_xor_b32 v11, v11, v12
    v_lshlrev_b32 v11, 4, v11
    v_lshl_add_u32 v2, v10, 10, v11
    s_lshl_b32 s3, s48, 15
    v_add_u32 v2, s3, v2
    v_xor_b32 v3, 64, v2
    v_add_u32 v3, 0x2000, v3
    v_add_u32 v4, 0x4000, v2
    v_add_u32 v5, 0x4000, v3
    s_lshl_b32 s49, s48, 12
    s_and_b32 s55, s31, 7
    s_lshl_b32 s52, s55, 7
    s_lshl_b32 s3, s29, 17
    s_mov_b32 s38, 131072
    s_mov_b32 s39, 0x20000
    s_mov_b32 m0, s49
    s_waitcnt lgkmcnt(0)
    s_add_u32 s36, s4, s3
    s_addc_u32 s37, s5, 0
    buffer_load_dwordx4 v2, s[36:39], s52 offen lds
    s_add_u32 m0, s49, 1024
    s_nop 0
    buffer_load_dwordx4 v3, s[36:39], s52 offen lds
    s_add_u32 m0, s49, 2048
    s_nop 0
    buffer_load_dwordx4 v4, s[36:39], s52 offen lds
    s_add_u32 m0, s49, 3072
    s_nop 0
    buffer_load_dwordx4 v5, s[36:39], s52 offen lds
    v_lshrrev_b32 v10, 2, v0
    s_lshl_b32 s3, s48, 4
    v_add_u32 v10, s3, v10
    v_and_b32 v12, 3, v0
    v_lshlrev_b32 v12, 4, v12
    v_lshl_add_u32 v6, v10, 10, v12
    s_lshl_b32 s3, s30, 6
    v_add_u32 v6, s3, v6
    s_and_b32 s3, s48, 1
    s_lshl_b32 s3, s3, 10
    v_add_u32 v7, s3, v1
    s_lshl_b32 s50, s48, 10
    s_cmp_eq_u32 s30, 15
    s_cselect_b64 vcc, -1, 0
    s_cselect_b32 s58, 11, 16
    s_cselect_b32 s59, 114688, 0
    s_add_u32 s59, s59, s50
    v_cndmask_b32 v9, v6, v7, vcc
    s_lshl_b32 s53, s55, s58
    s_cmp_lt_u32 s48, 2
    s_cselect_b32 s44, s8, s10
    s_cselect_b32 s45, s9, s11
    s_cmp_eq_u32 s30, 15
    s_cselect_b32 s44, s44, s6
    s_cselect_b32 s45, s45, s7
    s_lshl_b32 s46, 8, s58
    s_mov_b32 s47, 0x20000
    s_add_u32 m0, s59, 16384
    s_nop 0
    buffer_load_dwordx4 v9, s[44:47], s53 offen lds
    s_mov_b32 s32, s26
    s_mov_b32 s33, s27
    s_mov_b32 s34, 67108864
    s_mov_b32 s35, 0x20000
    v_lshlrev_b32 v17, 8, v0
    v_mov_b32 v18, 0
    s_mov_b32 s56, 393216
    s_cmp_lg_u32 s48, 0
    s_cbranch_scc1 L_nfi_1
    s_mov_b64 exec, 0xffff
    buffer_load_dword v18, v17, s[32:35], s56 offen sc1
    s_mov_b64 exec, -1
L_nfi_1:
    s_cmp_eq_u32 s30, 15
    s_cbranch_scc1 L_ldkv
    s_mul_i32 s51, s48, 3072
    v_mul_u32_u24 v11, 171, v0
    v_lshrrev_b32 v11, 11, v11
    v_mul_u32_u24 v12, 12, v11
    v_sub_u32 v12, v0, v12
    s_lshl_b32 s3, s48, 4
    v_add_u32 v11, s3, v11
    v_mul_u32_u24 v11, 2752, v11
    v_lshl_add_u32 v7, v12, 4, v11
    s_mul_i32 s3, s30, 192
    v_add_u32 v7, s3, v7
    s_cmp_eq_u32 s30, 14
    s_cselect_b32 s3, 4, 12
    v_cmp_le_u32 vcc, s3, v12
    v_mov_b32 v10, 0x10000000
    s_nop 0
    v_cndmask_b32 v7, v7, v10, vcc
    v_add_u32 v8, 11008, v7
    v_add_u32 v9, 22016, v7
    v_add_u32 v10, 33024, v7
    s_mov_b32 s40, s6
    s_mov_b32 s41, s7
    s_mov_b32 s42, 524288
    s_mov_b32 s43, 0x20000
    s_mov_b32 s44, s16
    s_mov_b32 s45, s17
    s_mov_b32 s46, 1409024
    s_mov_b32 s47, 0x20000
    s_and_b32 s55, s55, 7
    s_lshl_b32 s52, s55, 7
    s_lshl_b32 s53, s55, 16
    s_mul_i32 s54, s55, 176128
    s_add_u32 s55, s55, 1
    s_mov_b32 exec_hi, 0xffff
    s_add_u32 m0, s51, 20480
    s_nop 0
    buffer_load_dwordx4 v7, s[44:47], s54 offen lds
    s_add_u32 m0, s51, 21248
    s_nop 0
    buffer_load_dwordx4 v8, s[44:47], s54 offen lds
    s_add_u32 m0, s51, 22016
    s_nop 0
    buffer_load_dwordx4 v9, s[44:47], s54 offen lds
    s_add_u32 m0, s51, 22784
    s_nop 0
    buffer_load_dwordx4 v10, s[44:47], s54 offen lds
    s_mov_b32 exec_hi, -1
    v_and_b32 v50, 31, v0
    v_lshrrev_b32 v51, 5, v0
    v_mul_u32_u24 v156, 1040, v51
    v_lshl_add_u32 v156, v50, 4, v156
    v_lshlrev_b32 v51, 8, v51
    v_lshl_add_u32 v157, v50, 4, v51
    v_add_u32 v157, 512, v157
    s_mov_b32 exec_lo, 0xffff0000
    s_mov_b32 exec_hi, 0xffff0000
    v_mov_b32 v157, 0x1000000
    s_mov_b32 exec_lo, 0x00110000
    s_mov_b32 exec_hi, 0x00110000
    v_mov_b32 v157, 1024
    s_mov_b64 exec, -1
    v_mov_b32 v224, 0
    v_mov_b32 v225, 0
    v_mov_b32 v226, 0
    v_mov_b32 v227, 0
    v_mov_b32 v228, 0
    v_mov_b32 v229, 0
    v_mov_b32 v230, 0
    v_mov_b32 v231, 0
    v_mov_b32 v232, 0
    v_mov_b32 v233, 0
    v_mov_b32 v234, 0
    v_mov_b32 v235, 0
    v_mov_b32 v236, 0
    v_mov_b32 v237, 0
    v_mov_b32 v238, 0
    v_mov_b32 v239, 0
    v_mov_b32 v240, 0
    v_mov_b32 v241, 0
    v_mov_b32 v242, 0
    v_mov_b32 v243, 0
    v_mov_b32 v244, 0
    v_mov_b32 v245, 0
    v_mov_b32 v246, 0
    v_mov_b32 v247, 0
    v_mov_b32 v248, 0
    v_mov_b32 v249, 0
    v_mov_b32 v250, 0
    v_mov_b32 v251, 0
    v_mov_b32 v252, 0
    v_mov_b32 v253, 0
    v_mov_b32 v254, 0
    v_mov_b32 v255, 0
    v_mov_b32 v32, 0
    v_mov_b32 v33, 0
    v_mov_b32 v34, 0
    v_mov_b32 v35, 0
    s_lshl_b32 s3, s48, 7
    s_add_u32 s3, s3, 162944
    v_lshl_add_u32 v158, v50, 2, s3
    s_mul_i32 s3, s48, 7424
    s_add_u32 s3, s3, 133120
    v_add_u32 v159, s3, v1
    v_mov_b32 v55, 0x1000000
    v_mov_b32 v56, 1
    s_mov_b64 exec, 1
    v_mov_b32 v55, 162816
    s_mov_b64 exec, -1
    v_mov_b32 v54, 0xdddddddd
    v_lshlrev_b32 v15, 2, v0
    v_mov_b32 v20, 1
    v_mov_b32 v19, 0
    s_and_b32 s55, s55, 7
    s_lshl_b32 s52, s55, 7
    s_lshl_b32 s53, s55, 16
    s_mul_i32 s54, s55, 176128
    s_add_u32 s55, s55, 1
    s_add_u32 m0, s50, 49152
    s_nop 0
    buffer_load_dwordx4 v6, s[40:43], s53 offen lds
    s_mov_b32 exec_hi, 0xffff
    s_add_u32 m0, s51, 53248
    s_nop 0
    buffer_load_dwordx4 v7, s[44:47], s54 offen lds
    s_add_u32 m0, s51, 54016
    s_nop 0
    buffer_load_dwordx4 v8, s[44:47], s54 offen lds
    s_add_u32 m0, s51, 54784
    s_nop 0
    buffer_load_dwordx4 v9, s[44:47], s54 offen lds
    s_add_u32 m0, s51, 55552
    s_nop 0
    buffer_load_dwordx4 v10, s[44:47], s54 offen lds
    s_mov_b32 exec_hi, -1
    s_add_u32 m0, s49, 32768
    s_nop 0
    buffer_load_dwordx4 v2, s[36:39], s52 offen lds
    s_add_u32 m0, s49, 33792
    s_nop 0
    buffer_load_dwordx4 v3, s[36:39], s52 offen lds
    s_add_u32 m0, s49, 34816
    s_nop 0
    buffer_load_dwordx4 v4, s[36:39], s52 offen lds
    s_add_u32 m0, s49, 35840
    s_nop 0
    buffer_load_dwordx4 v5, s[36:39], s52 offen lds
    s_waitcnt vmcnt(9)
    s_barrier
    s_and_b32 s55, s55, 7
    s_lshl_b32 s52, s55, 7
    s_lshl_b32 s53, s55, 16
    s_mul_i32 s54, s55, 176128
    s_add_u32 s55, s55, 1
    s_add_u32 m0, s50, 81920
    s_nop 0
    buffer_load_dwordx4 v6, s[40:43], s53 offen lds
    s_mov_b32 exec_hi, 0xffff
    s_add_u32 m0, s51, 86016
    s_nop 0
    buffer_load_dwordx4 v7, s[44:47], s54 offen lds
    s_add_u32 m0, s51, 86784
    s_nop 0
    buffer_load_dwordx4 v8, s[44:47], s54 offen lds
    s_add_u32 m0, s51, 87552
    s_nop 0
    buffer_load_dwordx4 v9, s[44:47], s54 offen lds
    s_add_u32 m0, s51, 88320
    s_nop 0
    buffer_load_dwordx4 v10, s[44:47], s54 offen lds
    s_mov_b32 exec_hi, -1
    s_add_u32 m0, s49, 65536
    s_nop 0
    buffer_load_dwordx4 v2, s[36:39], s52 offen lds
    s_add_u32 m0, s49, 66560
    s_nop 0
    buffer_load_dwordx4 v3, s[36:39], s52 offen lds
    s_add_u32 m0, s49, 67584
    s_nop 0
    buffer_load_dwordx4 v4, s[36:39], s52 offen lds
    s_add_u32 m0, s49, 68608
    s_nop 0
    buffer_load_dwordx4 v5, s[36:39], s52 offen lds
    s_waitcnt vmcnt(9)
    s_barrier
    s_and_b32 s55, s55, 7
    s_lshl_b32 s52, s55, 7
    s_lshl_b32 s53, s55, 16
    s_mul_i32 s54, s55, 176128
    s_add_u32 s55, s55, 1
    s_add_u32 m0, s50, 114688
    s_nop 0
    buffer_load_dwordx4 v6, s[40:43], s53 offen lds
    s_mov_b32 exec_hi, 0xffff
    s_add_u32 m0, s51, 118784
    s_nop 0
    buffer_load_dwordx4 v7, s[44:47], s54 offen lds
    s_add_u32 m0, s51, 119552
    s_nop 0
    buffer_load_dwordx4 v8, s[44:47], s54 offen lds
    s_add_u32 m0, s51, 120320
    s_nop 0
    buffer_load_dwordx4 v9, s[44:47], s54 offen lds
    s_add_u32 m0, s51, 121088
    s_nop 0
    buffer_load_dwordx4 v10, s[44:47], s54 offen lds
    s_mov_b32 exec_hi, -1
    s_add_u32 m0, s49, 98304
    s_nop 0
    buffer_load_dwordx4 v2, s[36:39], s52 offen lds
    s_add_u32 m0, s49, 99328
    s_nop 0
    buffer_load_dwordx4 v3, s[36:39], s52 offen lds
    s_add_u32 m0, s49, 100352
    s_nop 0
    buffer_load_dwordx4 v4, s[36:39], s52 offen lds
    s_add_u32 m0, s49, 101376
    s_nop 0
    buffer_load_dwordx4 v5, s[36:39], s52 offen lds
    s_waitcnt vmcnt(9)
    s_barrier
    s_and_b32 s55, s55, 7
    s_lshl_b32 s52, s55, 7
    s_lshl_b32 s53, s55, 16
    s_mul_i32 s54, s55, 176128
    s_add_u32 s55, s55, 1
    s_add_u32 m0, s50, 16384
    s_nop 0
    buffer_load_dwordx4 v6, s[40:43], s53 offen lds
    s_mov_b32 exec_hi, 0xffff
    s_add_u32 m0, s51, 20480
    s_nop 0
    buffer_load_dwordx4 v7, s[44:47], s54 offen lds
    s_add_u32 m0, s51, 21248
    s_nop 0
    buffer_load_dwordx4 v8, s[44:47], s54 offen lds
    s_add_u32 m0, s51, 22016
    s_nop 0
    buffer_load_dwordx4 v9, s[44:47], s54 offen lds
    s_add_u32 m0, s51, 22784
    s_nop 0
    buffer_load_dwordx4 v10, s[44:47], s54 offen lds
    s_mov_b32 exec_hi, -1
    s_add_u32 m0, s49, 0
    s_nop 0
    buffer_load_dwordx4 v2, s[36:39], s52 offen lds
    s_add_u32 m0, s49, 1024
    s_nop 0
    buffer_load_dwordx4 v3, s[36:39], s52 offen lds
    s_add_u32 m0, s49, 2048
    s_nop 0
    buffer_load_dwordx4 v4, s[36:39], s52 offen lds
    s_add_u32 m0, s49, 3072
    s_nop 0
    buffer_load_dwordx4 v5, s[36:39], s52 offen lds
    s_waitcnt vmcnt(9)
    s_barrier
    s_and_b32 s55, s55, 7
    s_lshl_b32 s52, s55, 7
    s_lshl_b32 s53, s55, 16
    s_mul_i32 s54, s55, 176128
    s_add_u32 s55, s55, 1
    s_add_u32 m0, s50, 49152
    s_nop 0
    buffer_load_dwordx4 v6, s[40:43], s53 offen lds
    s_mov_b32 exec_hi, 0xffff
    s_add_u32 m0, s51, 53248
    s_nop 0
    buffer_load_dwordx4 v7, s[44:47], s54 offen lds
    s_add_u32 m0, s51, 54016
    s_nop 0
    buffer_load_dwordx4 v8, s[44:47], s54 offen lds
    s_add_u32 m0, s51, 54784
    s_nop 0
    buffer_load_dwordx4 v9, s[44:47], s54 offen lds
    s_add_u32 m0, s51, 55552
    s_nop 0
    buffer_load_dwordx4 v10, s[44:47], s54 offen lds
    s_mov_b32 exec_hi, -1
    s_add_u32 m0, s49, 32768
    s_nop 0
    buffer_load_dwordx4 v2, s[36:39], s52 offen lds
    s_add_u32 m0, s49, 33792
    s_nop 0
    buffer_load_dwordx4 v3, s[36:39], s52 offen lds
    s_add_u32 m0, s49, 34816
    s_nop 0
    buffer_load_dwordx4 v4, s[36:39], s52 offen lds
    s_add_u32 m0, s49, 35840
    s_nop 0
    buffer_load_dwordx4 v5, s[36:39], s52 offen lds
    s_waitcnt vmcnt(9)
    s_barrier
    s_and_b32 s55, s55, 7
    s_lshl_b32 s52, s55, 7
    s_lshl_b32 s53, s55, 16
    s_mul_i32 s54, s55, 176128
    s_add_u32 s55, s55, 1
    s_add_u32 m0, s50, 81920
    s_nop 0
    buffer_load_dwordx4 v6, s[40:43], s53 offen lds
    s_mov_b32 exec_hi, 0xffff
    s_add_u32 m0, s51, 86016
    s_nop 0
    buffer_load_dwordx4 v7, s[44:47], s54 offen lds
    s_add_u32 m0, s51, 86784
    s_nop 0
    buffer_load_dwordx4 v8, s[44:47], s54 offen lds
    s_add_u32 m0, s51, 87552
    s_nop 0
    buffer_load_dwordx4 v9, s[44:47], s54 offen lds
    s_add_u32 m0, s51, 88320
    s_nop 0
    buffer_load_dwordx4 v10, s[44:47], s54 offen lds
    s_mov_b32 exec_hi, -1
    s_add_u32 m0, s49, 65536
    s_nop 0
    buffer_load_dwordx4 v2, s[36:39], s52 offen lds
    s_add_u32 m0, s49, 66560
    s_nop 0
    buffer_load_dwordx4 v3, s[36:39], s52 offen lds
    s_add_u32 m0, s49, 67584
    s_nop 0
    buffer_load_dwordx4 v4, s[36:39], s52 offen lds
    s_add_u32 m0, s49, 68608
    s_nop 0
    buffer_load_dwordx4 v5, s[36:39], s52 offen lds
    s_waitcnt vmcnt(9)
    s_barrier
    s_and_b32 s55, s55, 7
    s_lshl_b32 s52, s55, 7
    s_lshl_b32 s53, s55, 16
    s_mul_i32 s54, s55, 176128
    s_add_u32 s55, s55, 1
    s_add_u32 m0, s50, 114688
    s_nop 0
    buffer_load_dwordx4 v6, s[40:43], s53 offen lds
    s_mov_b32 exec_hi, 0xffff
    s_add_u32 m0, s51, 118784
    s_nop 0
    buffer_load_dwordx4 v7, s[44:47], s54 offen lds
    s_add_u32 m0, s51, 119552
    s_nop 0
    buffer_load_dwordx4 v8, s[44:47], s54 offen lds
    s_add_u32 m0, s51, 120320
    s_nop 0
    buffer_load_dwordx4 v9, s[44:47], s54 offen lds
    s_add_u32 m0, s51, 121088
    s_nop 0
    buffer_load_dwordx4 v10, s[44:47], s54 offen lds
    s_mov_b32 exec_hi, -1
    s_add_u32 m0, s49, 98304
    s_nop 0
    buffer_load_dwordx4 v2, s[36:39], s52 offen lds
    s_add_u32 m0, s49, 99328
    s_nop 0
    buffer_load_dwordx4 v3, s[36:39], s52 offen lds
    s_add_u32 m0, s49, 100352
    s_nop 0
    buffer_load_dwordx4 v4, s[36:39], s52 offen lds
    s_add_u32 m0, s49, 101376
    s_nop 0
    buffer_load_dwordx4 v5, s[36:39], s52 offen lds
    s_waitcnt vmcnt(9)
    s_barrier
    s_waitcnt vmcnt(0)
    s_cmp_lg_u32 s48, 0
    s_cbranch_scc1 L_npi_2
    s_mov_b64 exec, 0xffff
    buffer_load_dword v20, v17, s[32:35], s56 offen sc1
    s_mov_b64 exec, -1
L_npi_2:
    s_barrier
L_attn:
    s_mov_b32 s44, s24
    s_mov_b32 s45, s25
    s_mov_b32 s46, 256
    s_mov_b32 s47, 0x20000
    s_add_u32 s52, s48, 0
    s_lshl_b32 s52, s52, 10
    s_bfe_u32 s53, s2, 0x40003
    s_mul_i32 s53, s53, 8320
    s_add_u32 s53, s53, s52
    s_sub_u32 s3, s53, 133120
    s_min_u32 s53, s53, s3
    s_cmp_lg_u32 s48, 0
    s_cbranch_scc1 L_kvo_5
L_kvw_3:
    s_waitcnt vmcnt(0)
    v_cmp_eq_u32 vcc, v18, v20
    s_cbranch_vccz L_kvd_4
    v_cmp_eq_u32 s[54:55], 0, v19
    s_sub_u32 s97, s97, 1
    s_cbranch_scc1 L_kvd_4
    s_and_b64 vcc, vcc, s[54:55]
    s_cbranch_scc0 L_kvd_4
    s_sleep 2
    s_mov_b64 exec, 0xffff
    buffer_load_dword v20, v17, s[32:35], s56 offen sc1
    s_mov_b64 exec, -1
    s_cmp_gt_u32 s97, 1048560
    s_cbranch_scc1 L_kvw_3
    s_mov_b64 exec, 0xffff
    buffer_load_dword v19, v15, s[44:47], 0 offen sc1
    s_mov_b64 exec, -1
    s_branch L_kvw_3
L_kvo_5:
    s_mov_b32 s97, 8388608
L_sp_7:
    ds_read_b32 v12, v55 offset:28
    s_waitcnt lgkmcnt(0)
    v_readfirstlane_b32 s3, v12
    s_sub_u32 s97, s97, 1
    s_cbranch_scc1 L_spd_8
    s_cmp_ge_u32 s3, 1
    s_cbranch_scc1 L_spd_8
    s_sleep 1
    s_branch L_sp_7
L_spd_8:
    s_mov_b32 s97, 1048576
    s_branch L_kvg_6
L_kvd_4:
    ds_add_u32 v55, v56 offset:28
L_kvg_6:
    s_mov_b32 s97, 1048576
    s_mov_b32 m0, s52
    s_add_u32 s52, s52, 4096
    buffer_load_dwordx4 v1, s[32:35], s53 offen sc1 lds
    s_add_u32 s53, s53, 4096
    s_sub_u32 s3, s53, 133120
    s_min_u32 s53, s53, s3
    s_mov_b32 m0, s52
    s_add_u32 s52, s52, 4096
    buffer_load_dwordx4 v1, s[32:35], s53 offen sc1 lds
    s_add_u32 s53, s53, 4096
    s_sub_u32 s3, s53, 133120
    s_min_u32 s53, s53, s3
    s_mov_b32 m0, s52
    s_add_u32 s52, s52, 4096
    buffer_load_dwordx4 v1, s[32:35], s53 offen sc1 lds
    s_add_u32 s53, s53, 4096
    s_sub_u32 s3, s53, 133120
    s_min_u32 s53, s53, s3
    s_mov_b32 m0, s52
    s_add_u32 s52, s52, 4096
    buffer_load_dwordx4 v1, s[32:35], s53 offen sc1 lds
    s_add_u32 s53, s53, 4096
    s_sub_u32 s3, s53, 133120
    s_min_u32 s53, s53, s3
    s_mov_b32 m0, s52
    s_add_u32 s52, s52, 4096
    buffer_load_dwordx4 v1, s[32:35], s53 offen sc1 lds
    s_add_u32 s53, s53, 4096
    s_sub_u32 s3, s53, 133120
    s_min_u32 s53, s53, s3
    s_mov_b32 m0, s52
    s_add_u32 s52, s52, 4096
    buffer_load_dwordx4 v1, s[32:35], s53 offen sc1 lds
    s_add_u32 s53, s53, 4096
    s_sub_u32 s3, s53, 133120
    s_min_u32 s53, s53, s3
    s_mov_b32 m0, s52
    s_add_u32 s52, s52, 4096
    buffer_load_dwordx4 v1, s[32:35], s53 offen sc1 lds
    s_add_u32 s53, s53, 4096
    s_sub_u32 s3, s53, 133120
    s_min_u32 s53, s53, s3
    s_mov_b32 m0, s52
    s_add_u32 s52, s52, 4096
    buffer_load_dwordx4 v1, s[32:35], s53 offen sc1 lds
    s_add_u32 s53, s53, 4096
    s_sub_u32 s3, s53, 133120
    s_min_u32 s53, s53, s3
    s_lshl_b32 s50, s29, 2
    s_add_u32 s50, s50, s48
    s_lshl_b32 s50, s50, 4
    s_add_u32 s50, s50, s30
    s_lshl_b32 s50, s50, 11
    s_add_u32 s50, s50, 3145728
    s_mov_b64 s[54:55], -1
    s_mov_b32 s52, 0
    s_setprio 3
    s_waitcnt vmcnt(0)
    ds_add_u32 v55, v56 offset:24
L_sp_9:
    ds_read_b32 v12, v55 offset:24
    s_waitcnt lgkmcnt(0)
    v_readfirstlane_b32 s3, v12
    s_sub_u32 s97, s97, 1
    s_cbranch_scc1 L_spd_10
    s_cmp_ge_u32 s3, 8
    s_cbranch_scc1 L_spd_10
    s_branch L_sp_9
L_spd_10:
    s_mov_b32 s97, 1048576
    ds_read_b128 v[12:15], v156
    ds_read_b128 v[4:7], v159
    ds_read_b128 v[8:11], v159 offset:1024
    s_waitcnt lgkmcnt(1)
    v_mfma_f32_32x32x16_bf16 v[64:79], v[12:15], v[4:7], 0
    s_waitcnt lgkmcnt(0)
    v_mfma_f32_32x32x16_bf16 v[80:95], v[12:15], v[8:11], 0
    ds_add_u32 v55, v56 offset:20
    s_nop 8
    v_max3_f32 v45, v64, v65, v66
    v_max3_f32 v45, v45, v67, v68
    v_max3_f32 v45, v45, v69, v70
    v_max3_f32 v45, v45, v71, v72
    v_max3_f32 v45, v45, v73, v74
    v_max3_f32 v45, v45, v75, v76
    v_max3_f32 v45, v45, v77, v78
    v_max_f32 v45, v45, v79
    v_max3_f32 v47, v80, v81, v82
    v_max3_f32 v47, v47, v83, v84
    v_max3_f32 v47, v47, v85, v86
    v_max3_f32 v47, v47, v87, v88
    v_max3_f32 v47, v47, v89, v90
    v_max3_f32 v47, v47, v91, v92
    v_max3_f32 v47, v47, v93, v94
    v_max_f32 v47, v47, v95
L_restart_11:
    v_mov_b32 v46, v45
    v_mov_b32 v48, v47
    ds_read_b128 v[20:23], v157
    ds_read_b128 v[24:27], v157 offset:1040
    v_permlane32_swap_b32 v45, v46
    v_permlane32_swap_b32 v47, v48
    ds_read_b128 v[16:19], v156 offset:2080
    s_mov_b32 s49, 0
    v_max_f32 v96, v45, v46
    v_max_f32 v112, v47, v48
    v_sub_f32 v96, 0, v96
    v_sub_f32 v112, 0, v112
    v_mov_b32 v97, v96
    v_mov_b32 v113, v112
    v_pk_mov_b32 v[98:99], v[96:97], v[96:97]
    v_pk_mov_b32 v[100:101], v[96:97], v[96:97]
    v_pk_mov_b32 v[102:103], v[96:97], v[96:97]
    v_pk_mov_b32 v[104:105], v[96:97], v[96:97]
    v_pk_mov_b32 v[106:107], v[96:97], v[96:97]
    v_pk_mov_b32 v[108:109], v[96:97], v[96:97]
    v_pk_mov_b32 v[110:111], v[96:97], v[96:97]
    v_pk_mov_b32 v[114:115], v[112:113], v[112:113]
    v_pk_mov_b32 v[116:117], v[112:113], v[112:113]
    v_mfma_f32_32x32x16_bf16 v[64:79], v[12:15], v[4:7], v[96:111]
    v_pk_mov_b32 v[118:119], v[112:113], v[112:113]
    v_pk_mov_b32 v[120:121], v[112:113], v[112:113]
    v_pk_mov_b32 v[122:123], v[112:113], v[112:113]
    v_pk_mov_b32 v[124:125], v[112:113], v[112:113]
    v_pk_mov_b32 v[126:127], v[112:113], v[112:113]
    s_waitcnt lgkmcnt(0)
    s_nop 4
    s_setprio 2
    v_exp_f32 v64, v64
    v_exp_f32 v65, v65
.p2align 6
L_aloop_12:
    v_smfmac_f32_32x32x32_bf16 v[240:255], v[32:35], v[88:95], v54
    ds_read_b128 v[28:31], v157 offset:2080
    v_exp_f32 v66, v66
    v_exp_f32 v67, v67
    v_exp_f32 v68, v68
    v_exp_f32 v69, v69
    v_mfma_f32_32x32x16_bf16 v[80:95], v[12:15], v[8:11], v[112:127]
    ds_read_b128 v[12:15], v156 offset:4160
    v_exp_f32 v70, v70
    v_exp_f32 v71, v71
    v_exp_f32 v72, v72
    v_exp_f32 v73, v73
    v_exp_f32 v74, v74
    v_exp_f32 v75, v75
    v_smfmac_f32_32x32x32_bf16 v[224:239], v[20:23], v[64:71], v54
    ds_read_b128 v[32:35], v157 offset:3120
    v_exp_f32 v76, v76
    v_exp_f32 v77, v77
    v_exp_f32 v78, v78
    v_exp_f32 v79, v79
    v_exp_f32 v80, v80
    v_exp_f32 v81, v81
    v_smfmac_f32_32x32x32_bf16 v[224:239], v[24:27], v[72:79], v54
    v_exp_f32 v82, v82
    v_exp_f32 v83, v83
    v_exp_f32 v84, v84
    v_exp_f32 v85, v85
    v_mfma_f32_32x32x16_bf16 v[64:79], v[16:19], v[4:7], v[96:111]
    v_exp_f32 v86, v86
    v_exp_f32 v87, v87
    v_exp_f32 v88, v88
    v_exp_f32 v89, v89
    v_exp_f32 v90, v90
    v_exp_f32 v91, v91
    v_smfmac_f32_32x32x32_bf16 v[240:255], v[20:23], v[80:87], v54
    s_waitcnt lgkmcnt(0)
    v_exp_f32 v92, v92
    v_exp_f32 v93, v93
    v_exp_f32 v94, v94
    v_exp_f32 v95, v95
    v_exp_f32 v64, v64
    v_exp_f32 v65, v65
    v_smfmac_f32_32x32x32_bf16 v[240:255], v[24:27], v[88:95], v54
    ds_read_b128 v[20:23], v157 offset:4160
    v_exp_f32 v66, v66
    v_exp_f32 v67, v67
    v_exp_f32 v68, v68
    v_exp_f32 v69, v69
    v_mfma_f32_32x32x16_bf16 v[80:95], v[16:19], v[8:11], v[112:127]
    ds_read_b128 v[16:19], v156 offset:6240
    v_exp_f32 v70, v70
    v_exp_f32 v71, v71
    v_exp_f32 v72, v72
    v_exp_f32 v73, v73
    v_exp_f32 v74, v74
    v_exp_f32 v75, v75
    v_smfmac_f32_32x32x32_bf16 v[224:239], v[28:31], v[64:71], v54
    ds_read_b128 v[24:27], v157 offset:5200
    v_exp_f32 v76, v76
    v_exp_f32 v77, v77
    v_exp_f32 v78, v78
    v_exp_f32 v79, v79
    v_exp_f32 v80, v80
    v_exp_f32 v81, v81
    v_smfmac_f32_32x32x32_bf16 v[224:239], v[32:35], v[72:79], v54
    v_exp_f32 v82, v82
    v_exp_f32 v83, v83
    v_exp_f32 v84, v84
    v_exp_f32 v85, v85
    v_mfma_f32_32x32x16_bf16 v[64:79], v[12:15], v[4:7], v[96:111]
    v_exp_f32 v86, v86
    v_exp_f32 v87, v87
    v_exp_f32 v88, v88
    v_exp_f32 v89, v89
    v_exp_f32 v90, v90
    v_exp_f32 v91, v91
    v_smfmac_f32_32x32x32_bf16 v[240:255], v[28:31], v[80:87], v54
    s_waitcnt lgkmcnt(0)
    v_exp_f32 v92, v92
    v_exp_f32 v93, v93
    v_exp_f32 v94, v94
    v_exp_f32 v95, v95
    v_exp_f32 v64, v64
    v_exp_f32 v65, v65
    v_smfmac_f32_32x32x32_bf16 v[240:255], v[32:35], v[88:95], v54
    ds_read_b128 v[28:31], v157 offset:6240
    v_exp_f32 v66, v66
    v_exp_f32 v67, v67
    v_exp_f32 v68, v68
    v_exp_f32 v69, v69
    v_mfma_f32_32x32x16_bf16 v[80:95], v[12:15], v[8:11], v[112:127]
    ds_read_b128 v[12:15], v156 offset:8320
    v_exp_f32 v70, v70
    v_exp_f32 v71, v71
    v_exp_f32 v72, v72
    v_exp_f32 v73, v73
    v_exp_f32 v74, v74
    v_exp_f32 v75, v75
    v_smfmac_f32_32x32x32_bf16 v[224:239], v[20:23], v[64:71], v54
    ds_read_b128 v[32:35], v157 offset:7280
    v_exp_f32 v76, v76
    v_exp_f32 v77, v77
    v_exp_f32 v78, v78
    v_exp_f32 v79, v79
    v_exp_f32 v80, v80
    v_exp_f32 v81, v81
    v_smfmac_f32_32x32x32_bf16 v[224:239], v[24:27], v[72:79], v54
    v_exp_f32 v82, v82
    v_exp_f32 v83, v83
    v_exp_f32 v84, v84
    v_exp_f32 v85, v85
    v_mfma_f32_32x32x16_bf16 v[64:79], v[16:19], v[4:7], v[96:111]
    v_exp_f32 v86, v86
    v_exp_f32 v87, v87
    v_exp_f32 v88, v88
    v_exp_f32 v89, v89
    v_exp_f32 v90, v90
    v_exp_f32 v91, v91
    v_smfmac_f32_32x32x32_bf16 v[240:255], v[20:23], v[80:87], v54
    s_waitcnt lgkmcnt(0)
    v_exp_f32 v92, v92
    v_exp_f32 v93, v93
    v_exp_f32 v94, v94
    v_exp_f32 v95, v95
    v_exp_f32 v64, v64
    v_exp_f32 v65, v65
    v_smfmac_f32_32x32x32_bf16 v[240:255], v[24:27], v[88:95], v54
    ds_read_b128 v[20:23], v157 offset:8320
    v_exp_f32 v66, v66
    v_exp_f32 v67, v67
    v_exp_f32 v68, v68
    v_exp_f32 v69, v69
    v_mfma_f32_32x32x16_bf16 v[80:95], v[16:19], v[8:11], v[112:127]
    ds_read_b128 v[16:19], v156 offset:10400
    v_exp_f32 v70, v70
    v_exp_f32 v71, v71
    v_exp_f32 v72, v72
    v_exp_f32 v73, v73
    v_exp_f32 v74, v74
    v_exp_f32 v75, v75
    v_smfmac_f32_32x32x32_bf16 v[224:239], v[28:31], v[64:71], v54
    ds_read_b128 v[24:27], v157 offset:9360
    v_exp_f32 v76, v76
    v_exp_f32 v77, v77
    v_exp_f32 v78, v78
    v_exp_f32 v79, v79
    v_exp_f32 v80, v80
    v_exp_f32 v81, v81
    v_smfmac_f32_32x32x32_bf16 v[224:239], v[32:35], v[72:79], v54
    v_exp_f32 v82, v82
    v_exp_f32 v83, v83
    v_exp_f32 v84, v84
    v_exp_f32 v85, v85
    v_mfma_f32_32x32x16_bf16 v[64:79], v[12:15], v[4:7], v[96:111]
    v_exp_f32 v86, v86
    v_exp_f32 v87, v87
    v_exp_f32 v88, v88
    v_exp_f32 v89, v89
    v_exp_f32 v90, v90
    v_exp_f32 v91, v91
    v_smfmac_f32_32x32x32_bf16 v[240:255], v[28:31], v[80:87], v54
    s_waitcnt lgkmcnt(0)
    v_exp_f32 v92, v92
    v_exp_f32 v93, v93
    v_exp_f32 v94, v94
    v_exp_f32 v95, v95
    v_exp_f32 v64, v64
    v_exp_f32 v65, v65
    v_smfmac_f32_32x32x32_bf16 v[240:255], v[32:35], v[88:95], v54
    ds_read_b128 v[28:31], v157 offset:10400
    v_exp_f32 v66, v66
    v_exp_f32 v67, v67
    v_exp_f32 v68, v68
    v_exp_f32 v69, v69
    v_mfma_f32_32x32x16_bf16 v[80:95], v[12:15], v[8:11], v[112:127]
    ds_read_b128 v[12:15], v156 offset:12480
    v_exp_f32 v70, v70
    v_exp_f32 v71, v71
    v_exp_f32 v72, v72
    v_exp_f32 v73, v73
    v_exp_f32 v74, v74
    v_exp_f32 v75, v75
    v_smfmac_f32_32x32x32_bf16 v[224:239], v[20:23], v[64:71], v54
    ds_read_b128 v[32:35], v157 offset:11440
    v_exp_f32 v76, v76
    v_exp_f32 v77, v77
    v_exp_f32 v78, v78
    v_exp_f32 v79, v79
    v_exp_f32 v80, v80
    v_exp_f32 v81, v81
    v_smfmac_f32_32x32x32_bf16 v[224:239], v[24:27], v[72:79], v54
    v_exp_f32 v82, v82
    v_exp_f32 v83, v83
    v_exp_f32 v84, v84
    v_exp_f32 v85, v85
    v_mfma_f32_32x32x16_bf16 v[64:79], v[16:19], v[4:7], v[96:111]
    v_exp_f32 v86, v86
    v_exp_f32 v87, v87
    v_exp_f32 v88, v88
    v_exp_f32 v89, v89
    v_exp_f32 v90, v90
    v_exp_f32 v91, v91
    v_smfmac_f32_32x32x32_bf16 v[240:255], v[20:23], v[80:87], v54
    s_waitcnt lgkmcnt(0)
    v_exp_f32 v92, v92
    v_exp_f32 v93, v93
    v_exp_f32 v94, v94
    v_exp_f32 v95, v95
    v_exp_f32 v64, v64
    v_exp_f32 v65, v65
    v_smfmac_f32_32x32x32_bf16 v[240:255], v[24:27], v[88:95], v54
    ds_read_b128 v[20:23], v157 offset:12480
    v_exp_f32 v66, v66
    v_exp_f32 v67, v67
    v_exp_f32 v68, v68
    v_exp_f32 v69, v69
    v_mfma_f32_32x32x16_bf16 v[80:95], v[16:19], v[8:11], v[112:127]
    ds_read_b128 v[16:19], v156 offset:14560
    v_exp_f32 v70, v70
    v_exp_f32 v71, v71
    v_exp_f32 v72, v72
    v_exp_f32 v73, v73
    v_exp_f32 v74, v74
    v_exp_f32 v75, v75
    v_smfmac_f32_32x32x32_bf16 v[224:239], v[28:31], v[64:71], v54
    ds_read_b128 v[24:27], v157 offset:13520
    v_exp_f32 v76, v76
    v_exp_f32 v77, v77
    v_exp_f32 v78, v78
    v_exp_f32 v79, v79
    v_exp_f32 v80, v80
    v_exp_f32 v81, v81
    v_smfmac_f32_32x32x32_bf16 v[224:239], v[32:35], v[72:79], v54
    s_add_u32 s49, s49, 1
    v_exp_f32 v82, v82
    v_exp_f32 v83, v83
    v_exp_f32 v84, v84
    v_exp_f32 v85, v85
    v_mfma_f32_32x32x16_bf16 v[64:79], v[12:15], v[4:7], v[96:111]
    v_exp_f32 v86, v86
    v_exp_f32 v87, v87
    v_exp_f32 v88, v88
    v_exp_f32 v89, v89
    v_exp_f32 v90, v90
    v_exp_f32 v91, v91
    v_smfmac_f32_32x32x32_bf16 v[240:255], v[28:31], v[80:87], v54
    s_waitcnt lgkmcnt(0)
    v_exp_f32 v92, v92
    v_exp_f32 v93, v93
    v_exp_f32 v94, v94
    v_exp_f32 v95, v95
    v_exp_f32 v64, v64
    v_exp_f32 v65, v65
    v_smfmac_f32_32x32x32_bf16 v[240:255], v[32:35], v[88:95], v54
    ds_read_b128 v[28:31], v157 offset:14560
    v_exp_f32 v66, v66
    v_exp_f32 v67, v67
    v_exp_f32 v68, v68
    v_exp_f32 v69, v69
    v_mfma_f32_32x32x16_bf16 v[80:95], v[12:15], v[8:11], v[112:127]
    ds_read_b128 v[12:15], v156 offset:16640
    v_exp_f32 v70, v70
    v_exp_f32 v71, v71
    v_exp_f32 v72, v72
    v_exp_f32 v73, v73
    v_exp_f32 v74, v74
    v_exp_f32 v75, v75
    v_smfmac_f32_32x32x32_bf16 v[224:239], v[20:23], v[64:71], v54
    ds_read_b128 v[32:35], v157 offset:15600
    v_exp_f32 v76, v76
    v_exp_f32 v77, v77
    v_exp_f32 v78, v78
    v_exp_f32 v79, v79
    v_exp_f32 v80, v80
    v_exp_f32 v81, v81
    v_smfmac_f32_32x32x32_bf16 v[224:239], v[24:27], v[72:79], v54
    ds_read_b64 v[52:53], v55
    v_exp_f32 v82, v82
    v_exp_f32 v83, v83
    v_exp_f32 v84, v84
    v_exp_f32 v85, v85
    v_mfma_f32_32x32x16_bf16 v[64:79], v[16:19], v[4:7], v[96:111]
    v_exp_f32 v86, v86
    v_exp_f32 v87, v87
    v_exp_f32 v88, v88
    v_exp_f32 v89, v89
    v_exp_f32 v90, v90
    v_exp_f32 v91, v91
    v_smfmac_f32_32x32x32_bf16 v[240:255], v[20:23], v[80:87], v54
    s_waitcnt lgkmcnt(0)
    v_exp_f32 v92, v92
    v_exp_f32 v93, v93
    v_exp_f32 v94, v94
    v_exp_f32 v95, v95
    v_exp_f32 v64, v64
    v_exp_f32 v65, v65
    v_smfmac_f32_32x32x32_bf16 v[240:255], v[24:27], v[88:95], v54
    ds_read_b128 v[20:23], v157 offset:16640
    v_exp_f32 v66, v66
    v_exp_f32 v67, v67
    v_exp_f32 v68, v68
    v_exp_f32 v69, v69
    v_mfma_f32_32x32x16_bf16 v[80:95], v[16:19], v[8:11], v[112:127]
    ds_read_b128 v[16:19], v156 offset:18720
    v_exp_f32 v70, v70
    v_exp_f32 v71, v71
    v_exp_f32 v72, v72
    v_exp_f32 v73, v73
    v_exp_f32 v74, v74
    v_exp_f32 v75, v75
    v_smfmac_f32_32x32x32_bf16 v[224:239], v[28:31], v[64:71], v54
    ds_read_b128 v[24:27], v157 offset:17680
    v_exp_f32 v76, v76
    v_exp_f32 v77, v77
    v_exp_f32 v78, v78
    v_exp_f32 v79, v79
    v_exp_f32 v80, v80
    v_exp_f32 v81, v81
    v_smfmac_f32_32x32x32_bf16 v[224:239], v[32:35], v[72:79], v54
    ds_read_b32 v44, v158
    v_exp_f32 v82, v82
    v_exp_f32 v83, v83
    v_exp_f32 v84, v84
    v_exp_f32 v85, v85
    v_mfma_f32_32x32x16_bf16 v[64:79], v[12:15], v[4:7], v[96:111]
    s_cmp_eq_u32 s49, 1
    v_exp_f32 v86, v86
    v_exp_f32 v87, v87
    v_exp_f32 v88, v88
    v_exp_f32 v89, v89
    v_exp_f32 v90, v90
    v_exp_f32 v91, v91
    v_smfmac_f32_32x32x32_bf16 v[240:255], v[28:31], v[80:87], v54
    s_waitcnt lgkmcnt(0)
    v_exp_f32 v92, v92
    v_exp_f32 v93, v93
    v_exp_f32 v94, v94
    v_exp_f32 v95, v95
    v_add_u32 v156, 16640, v156
    v_add_u32 v157, 16640, v157
    v_exp_f32 v64, v64
    v_exp_f32 v65, v65
    s_cbranch_scc1 L_chk_13
    s_cmp_lt_u32 s49, 7
    s_cbranch_scc1 L_aloop_12
    v_smfmac_f32_32x32x32_bf16 v[240:255], v[32:35], v[88:95], v54
    ds_read_b128 v[160:163], v157 offset:2080
    v_exp_f32 v66, v66
    v_exp_f32 v67, v67
    v_exp_f32 v68, v68
    v_exp_f32 v69, v69
    v_mfma_f32_32x32x16_bf16 v[80:95], v[16:19], v[4:7], v[96:111]
    ds_read_b128 v[128:131], v156 offset:4160
    v_exp_f32 v70, v70
    v_exp_f32 v71, v71
    v_exp_f32 v72, v72
    v_exp_f32 v73, v73
    v_exp_f32 v74, v74
    v_exp_f32 v75, v75
    v_smfmac_f32_32x32x32_bf16 v[224:239], v[20:23], v[64:71], v54
    ds_read_b128 v[164:167], v157 offset:3120
    v_exp_f32 v76, v76
    v_exp_f32 v77, v77
    v_exp_f32 v78, v78
    v_exp_f32 v79, v79
    v_exp_f32 v80, v80
    v_exp_f32 v81, v81
    v_smfmac_f32_32x32x32_bf16 v[224:239], v[24:27], v[72:79], v54
    ds_read_b128 v[168:171], v157 offset:4160
    v_exp_f32 v82, v82
    v_exp_f32 v83, v83
    v_exp_f32 v84, v84
    v_exp_f32 v85, v85
    s_waitcnt lgkmcnt(1)
    v_mfma_f32_32x32x16_bf16 v[64:79], v[128:131], v[4:7], v[96:111]
    ds_read_b128 v[132:135], v156 offset:6240
    v_exp_f32 v86, v86
    v_exp_f32 v87, v87
    v_exp_f32 v88, v88
    v_exp_f32 v89, v89
    v_exp_f32 v90, v90
    v_exp_f32 v91, v91
    v_smfmac_f32_32x32x32_bf16 v[224:239], v[160:163], v[80:87], v54
    ds_read_b128 v[172:175], v157 offset:5200
    v_exp_f32 v92, v92
    v_exp_f32 v93, v93
    v_exp_f32 v94, v94
    v_exp_f32 v95, v95
    v_exp_f32 v64, v64
    v_exp_f32 v65, v65
    v_smfmac_f32_32x32x32_bf16 v[224:239], v[164:167], v[88:95], v54
    ds_read_b128 v[176:179], v157 offset:6240
    v_exp_f32 v66, v66
    v_exp_f32 v67, v67
    v_exp_f32 v68, v68
    v_exp_f32 v69, v69
    s_waitcnt lgkmcnt(1)
    v_mfma_f32_32x32x16_bf16 v[80:95], v[132:135], v[4:7], v[96:111]
    ds_read_b128 v[136:139], v156 offset:8320
    v_exp_f32 v70, v70
    v_exp_f32 v71, v71
    v_exp_f32 v72, v72
    v_exp_f32 v73, v73
    v_exp_f32 v74, v74
    v_exp_f32 v75, v75
    v_smfmac_f32_32x32x32_bf16 v[224:239], v[168:171], v[64:71], v54
    ds_read_b128 v[180:183], v157 offset:7280
    v_exp_f32 v76, v76
    v_exp_f32 v77, v77
    v_exp_f32 v78, v78
    v_exp_f32 v79, v79
    v_exp_f32 v80, v80
    v_exp_f32 v81, v81
    v_smfmac_f32_32x32x32_bf16 v[224:239], v[172:175], v[72:79], v54
    ds_read_b128 v[184:187], v157 offset:8320
    v_exp_f32 v82, v82
    v_exp_f32 v83, v83
    v_exp_f32 v84, v84
    v_exp_f32 v85, v85
    s_waitcnt lgkmcnt(1)
    v_mfma_f32_32x32x16_bf16 v[64:79], v[136:139], v[4:7], v[96:111]
    ds_read_b128 v[140:143], v156 offset:10400
    v_exp_f32 v86, v86
    v_exp_f32 v87, v87
    v_exp_f32 v88, v88
    v_exp_f32 v89, v89
    v_exp_f32 v90, v90
    v_exp_f32 v91, v91
    v_smfmac_f32_32x32x32_bf16 v[224:239], v[176:179], v[80:87], v54
    ds_read_b128 v[188:191], v157 offset:9360
    v_exp_f32 v92, v92
    v_exp_f32 v93, v93
    v_exp_f32 v94, v94
    v_exp_f32 v95, v95
    v_exp_f32 v64, v64
    v_exp_f32 v65, v65
    v_smfmac_f32_32x32x32_bf16 v[224:239], v[180:183], v[88:95], v54
    ds_read_b128 v[192:195], v157 offset:10400
    v_exp_f32 v66, v66
    v_exp_f32 v67, v67
    v_exp_f32 v68, v68
    v_exp_f32 v69, v69
    s_waitcnt lgkmcnt(1)
    v_mfma_f32_32x32x16_bf16 v[80:95], v[140:143], v[4:7], v[96:111]
    ds_read_b128 v[144:147], v156 offset:12480
    v_exp_f32 v70, v70
    v_exp_f32 v71, v71
    v_exp_f32 v72, v72
    v_exp_f32 v73, v73
    v_exp_f32 v74, v74
    v_exp_f32 v75, v75
    v_smfmac_f32_32x32x32_bf16 v[224:239], v[184:187], v[64:71], v54
    ds_read_b128 v[196:199], v157 offset:11440
    v_exp_f32 v76, v76
    v_exp_f32 v77, v77
    v_exp_f32 v78, v78
    v_exp_f32 v79, v79
    v_exp_f32 v80, v80
    v_exp_f32 v81, v81
    v_smfmac_f32_32x32x32_bf16 v[224:239], v[188:191], v[72:79], v54
    ds_read_b128 v[200:203], v157 offset:12480
    v_exp_f32 v82, v82
    v_exp_f32 v83, v83
    v_exp_f32 v84, v84
    v_exp_f32 v85, v85
    s_waitcnt lgkmcnt(1)
    v_mfma_f32_32x32x16_bf16 v[64:79], v[144:147], v[4:7], v[96:111]
    ds_read_b128 v[148:151], v156 offset:14560
    v_exp_f32 v86, v86
    v_exp_f32 v87, v87
    v_exp_f32 v88, v88
    v_exp_f32 v89, v89
    v_exp_f32 v90, v90
    v_exp_f32 v91, v91
    v_smfmac_f32_32x32x32_bf16 v[224:239], v[192:195], v[80:87], v54
    ds_read_b128 v[204:207], v157 offset:13520
    v_exp_f32 v92, v92
    v_exp_f32 v93, v93
    v_exp_f32 v94, v94
    v_exp_f32 v95, v95
    v_exp_f32 v64, v64
    v_exp_f32 v65, v65
    v_smfmac_f32_32x32x32_bf16 v[224:239], v[196:199], v[88:95], v54
    ds_read_b128 v[208:211], v157 offset:14560
    v_exp_f32 v66, v66
    v_exp_f32 v67, v67
    v_exp_f32 v68, v68
    v_exp_f32 v69, v69
    s_waitcnt lgkmcnt(1)
    v_mfma_f32_32x32x16_bf16 v[80:95], v[148:151], v[4:7], v[96:111]
    v_exp_f32 v70, v70
    v_exp_f32 v71, v71
    v_exp_f32 v72, v72
    v_exp_f32 v73, v73
    v_exp_f32 v74, v74
    v_exp_f32 v75, v75
    v_smfmac_f32_32x32x32_bf16 v[224:239], v[200:203], v[64:71], v54
    ds_read_b128 v[212:215], v157 offset:15600
    v_exp_f32 v76, v76
    v_exp_f32 v77, v77
    v_exp_f32 v78, v78
    v_exp_f32 v79, v79
    v_exp_f32 v80, v80
    v_exp_f32 v81, v81
    v_smfmac_f32_32x32x32_bf16 v[224:239], v[204:207], v[72:79], v54
    s_mov_b32 s51, 0x5d800000
    v_exp_f32 v82, v82
    v_exp_f32 v83, v83
    v_exp_f32 v84, v84
    v_exp_f32 v85, v85
    s_waitcnt lgkmcnt(0)
    v_mfma_f32_32x32x16_bf16 v[64:79], v[12:15], v[8:11], v[112:127]
    v_exp_f32 v86, v86
    v_exp_f32 v87, v87
    v_exp_f32 v88, v88
    v_exp_f32 v89, v89
    v_exp_f32 v90, v90
    v_exp_f32 v91, v91
    v_smfmac_f32_32x32x32_bf16 v[224:239], v[208:211], v[80:87], v54
    s_nop 0
    v_readfirstlane_b32 s3, v53
    s_cmp_ge_u32 s3, 4
    s_cbranch_scc0 L_gw_15
L_gd_14:
    v_mul_f32 v49, 0xbfb8aa3b, v44
    v_exp_f32 v49, v49
    v_exp_f32 v92, v92
    v_exp_f32 v93, v93
    v_exp_f32 v94, v94
    v_exp_f32 v95, v95
    v_add_f32 v49, 1.0, v49
    v_exp_f32 v64, v64
    v_exp_f32 v65, v65
    v_smfmac_f32_32x32x32_bf16 v[224:239], v[212:215], v[88:95], v54
    v_exp_f32 v66, v66
    v_exp_f32 v67, v67
    v_exp_f32 v68, v68
    v_exp_f32 v69, v69
    v_mfma_f32_32x32x16_bf16 v[80:95], v[16:19], v[8:11], v[112:127]
    v_exp_f32 v70, v70
    v_exp_f32 v71, v71
    v_exp_f32 v72, v72
    v_exp_f32 v73, v73
    v_exp_f32 v74, v74
    v_exp_f32 v75, v75
    v_smfmac_f32_32x32x32_bf16 v[240:255], v[20:23], v[64:71], v54
    s_nop 0
    v_exp_f32 v76, v76
    v_exp_f32 v77, v77
    v_exp_f32 v78, v78
    v_exp_f32 v79, v79
    v_cmp_nge_f32 vcc, s51, v232
    v_mul_f32 v58, v49, v232
    v_rcp_f32 v58, v58
    s_and_b64 vcc, vcc, s[54:55]
    s_cselect_b32 s53, 1, 0
    s_cbranch_scc1 L_nost_17
    v_pk_mul_f32 v[224:225], v[224:225], v[58:59] op_sel_hi:[1,0]
    v_pk_mul_f32 v[226:227], v[226:227], v[58:59] op_sel_hi:[1,0]
    v_pk_mul_f32 v[228:229], v[228:229], v[58:59] op_sel_hi:[1,0]
    v_pk_mul_f32 v[230:231], v[230:231], v[58:59] op_sel_hi:[1,0]
    v_cvt_pk_bf16_f32 v36, v224, v225
    v_cvt_pk_bf16_f32 v37, v226, v227
    v_cvt_pk_bf16_f32 v38, v228, v229
    v_cvt_pk_bf16_f32 v39, v230, v231
    v_min_u32 v36, -2, v36
    v_min_u32 v37, -2, v37
    v_min_u32 v38, -2, v38
    v_min_u32 v39, -2, v39
    buffer_store_dwordx4 v[36:39], v1, s[32:35], s50 offen offset:0 sc1
L_nost_17:
    v_exp_f32 v80, v80
    v_exp_f32 v81, v81
    v_smfmac_f32_32x32x32_bf16 v[240:255], v[24:27], v[72:79], v54
    v_exp_f32 v82, v82
    v_exp_f32 v83, v83
    v_exp_f32 v84, v84
    v_exp_f32 v85, v85
    v_mfma_f32_32x32x16_bf16 v[64:79], v[128:131], v[8:11], v[112:127]
    v_exp_f32 v86, v86
    v_exp_f32 v87, v87
    v_exp_f32 v88, v88
    v_exp_f32 v89, v89
    v_exp_f32 v90, v90
    v_exp_f32 v91, v91
    v_smfmac_f32_32x32x32_bf16 v[240:255], v[160:163], v[80:87], v54
    s_nop 0
    v_exp_f32 v92, v92
    v_exp_f32 v93, v93
    v_exp_f32 v94, v94
    v_exp_f32 v95, v95
    v_exp_f32 v64, v64
    v_exp_f32 v65, v65
    v_smfmac_f32_32x32x32_bf16 v[240:255], v[164:167], v[88:95], v54
    v_exp_f32 v66, v66
    v_exp_f32 v67, v67
    v_exp_f32 v68, v68
    v_exp_f32 v69, v69
    v_mfma_f32_32x32x16_bf16 v[80:95], v[132:135], v[8:11], v[112:127]
    v_exp_f32 v70, v70
    v_exp_f32 v71, v71
    v_exp_f32 v72, v72
    v_exp_f32 v73, v73
    v_exp_f32 v74, v74
    v_exp_f32 v75, v75
    v_smfmac_f32_32x32x32_bf16 v[240:255], v[168:171], v[64:71], v54
    s_nop 0
    v_exp_f32 v76, v76
    v_exp_f32 v77, v77
    v_exp_f32 v78, v78
    v_exp_f32 v79, v79
    v_exp_f32 v80, v80
    v_exp_f32 v81, v81
    v_smfmac_f32_32x32x32_bf16 v[240:255], v[172:175], v[72:79], v54
    v_exp_f32 v82, v82
    v_exp_f32 v83, v83
    v_exp_f32 v84, v84
    v_exp_f32 v85, v85
    v_mfma_f32_32x32x16_bf16 v[64:79], v[136:139], v[8:11], v[112:127]
    v_exp_f32 v86, v86
    v_exp_f32 v87, v87
    v_exp_f32 v88, v88
    v_exp_f32 v89, v89
    v_exp_f32 v90, v90
    v_exp_f32 v91, v91
    v_smfmac_f32_32x32x32_bf16 v[240:255], v[176:179], v[80:87], v54
    s_nop 0
    v_exp_f32 v92, v92
    v_exp_f32 v93, v93
    v_exp_f32 v94, v94
    v_exp_f32 v95, v95
    v_exp_f32 v64, v64
    v_exp_f32 v65, v65
    v_smfmac_f32_32x32x32_bf16 v[240:255], v[180:183], v[88:95], v54
    v_exp_f32 v66, v66
    v_exp_f32 v67, v67
    v_exp_f32 v68, v68
    v_exp_f32 v69, v69
    v_mfma_f32_32x32x16_bf16 v[80:95], v[140:143], v[8:11], v[112:127]
    v_exp_f32 v70, v70
    v_exp_f32 v71, v71
    v_exp_f32 v72, v72
    v_exp_f32 v73, v73
    v_exp_f32 v74, v74
    v_exp_f32 v75, v75
    v_smfmac_f32_32x32x32_bf16 v[240:255], v[184:187], v[64:71], v54
    s_nop 0
    v_exp_f32 v76, v76
    v_exp_f32 v77, v77
    v_exp_f32 v78, v78
    v_exp_f32 v79, v79
    v_exp_f32 v80, v80
    v_exp_f32 v81, v81
    v_smfmac_f32_32x32x32_bf16 v[240:255], v[188:191], v[72:79], v54
    v_exp_f32 v82, v82
    v_exp_f32 v83, v83
    v_exp_f32 v84, v84
    v_exp_f32 v85, v85
    v_mfma_f32_32x32x16_bf16 v[64:79], v[144:147], v[8:11], v[112:127]
    v_exp_f32 v86, v86
    v_exp_f32 v87, v87
    v_exp_f32 v88, v88
    v_exp_f32 v89, v89
    v_exp_f32 v90, v90
    v_exp_f32 v91, v91
    v_smfmac_f32_32x32x32_bf16 v[240:255], v[192:195], v[80:87], v54
    s_nop 0
    v_exp_f32 v92, v92
    v_exp_f32 v93, v93
    v_exp_f32 v94, v94
    v_exp_f32 v95, v95
    v_exp_f32 v64, v64
    v_exp_f32 v65, v65
    v_smfmac_f32_32x32x32_bf16 v[240:255], v[196:199], v[88:95], v54
    v_exp_f32 v66, v66
    v_exp_f32 v67, v67
    v_exp_f32 v68, v68
    v_exp_f32 v69, v69
    v_mfma_f32_32x32x16_bf16 v[80:95], v[148:151], v[8:11], v[112:127]
    v_exp_f32 v70, v70
    v_exp_f32 v71, v71
    v_exp_f32 v72, v72
    v_exp_f32 v73, v73
    v_exp_f32 v74, v74
    v_exp_f32 v75, v75
    v_smfmac_f32_32x32x32_bf16 v[240:255], v[200:203], v[64:71], v54
    s_nop 0
    v_exp_f32 v76, v76
    v_exp_f32 v77, v77
    v_exp_f32 v78, v78
    v_exp_f32 v79, v79
    v_exp_f32 v80, v80
    v_exp_f32 v81, v81
    v_smfmac_f32_32x32x32_bf16 v[240:255], v[204:207], v[72:79], v54
    v_exp_f32 v82, v82
    v_exp_f32 v83, v83
    v_exp_f32 v84, v84
    v_exp_f32 v85, v85
    v_exp_f32 v86, v86
    v_exp_f32 v87, v87
    v_exp_f32 v88, v88
    v_exp_f32 v89, v89
    v_exp_f32 v90, v90
    v_exp_f32 v91, v91
    v_smfmac_f32_32x32x32_bf16 v[240:255], v[208:211], v[80:87], v54
    s_nop 0
    v_exp_f32 v92, v92
    v_exp_f32 v93, v93
    v_exp_f32 v94, v94
    v_exp_f32 v95, v95
    s_nop 1
    v_smfmac_f32_32x32x32_bf16 v[240:255], v[212:215], v[88:95], v54
    s_cmp_lg_u32 s53, 0
    s_cbranch_scc1 L_fb0_16
    s_nop 9
    v_cmp_nge_f32 vcc, s51, v248
    v_mul_f32 v58, v49, v248
    v_rcp_f32 v58, v58
    s_and_b64 vcc, vcc, s[54:55]
    s_cbranch_scc1 L_fb0_16
    v_pk_mul_f32 v[240:241], v[240:241], v[58:59] op_sel_hi:[1,0]
    v_pk_mul_f32 v[242:243], v[242:243], v[58:59] op_sel_hi:[1,0]
    v_pk_mul_f32 v[244:245], v[244:245], v[58:59] op_sel_hi:[1,0]
    v_pk_mul_f32 v[246:247], v[246:247], v[58:59] op_sel_hi:[1,0]
    v_cvt_pk_bf16_f32 v40, v240, v241
    v_cvt_pk_bf16_f32 v41, v242, v243
    v_cvt_pk_bf16_f32 v42, v244, v245
    v_cvt_pk_bf16_f32 v43, v246, v247
    v_min_u32 v40, -2, v40
    v_min_u32 v41, -2, v41
    v_min_u32 v42, -2, v42
    v_min_u32 v43, -2, v43
    buffer_store_dwordx4 v[40:43], v1, s[32:35], s50 offen offset:1024 sc1
L_nost_18:
    s_barrier
    s_endpgm
L_gw_15:
    s_mov_b32 s97, 8388608
L_sp_19:
    ds_read_b32 v57, v55 offset:4
    s_waitcnt lgkmcnt(0)
    v_readfirstlane_b32 s3, v57
    s_sub_u32 s97, s97, 1
    s_cbranch_scc1 L_spd_20
    s_cmp_ge_u32 s3, 4
    s_cbranch_scc1 L_spd_20
    s_sleep 1
    s_branch L_sp_19
L_spd_20:
    s_mov_b32 s97, 1048576
    ds_read_b32 v44, v158
    s_waitcnt lgkmcnt(0)
    s_branch L_gd_14
L_chk_13:
    v_readfirstlane_b32 s3, v52
    s_cmp_ge_u32 s3, 4
    s_cbranch_scc1 L_aloop_12
L_sp_21:
    ds_read_b32 v52, v55 offset:0
    s_waitcnt lgkmcnt(0)
    v_readfirstlane_b32 s3, v52
    s_sub_u32 s97, s97, 1
    s_cbranch_scc1 L_spd_22
    s_cmp_ge_u32 s3, 4
    s_cbranch_scc1 L_spd_22
    s_branch L_sp_21
L_spd_22:
    s_mov_b32 s97, 1048576
    s_branch L_aloop_12
L_fb0_16:
    s_mov_b64 s[54:55], 0
    v_and_b32 v50, 31, v0
    v_lshrrev_b32 v51, 5, v0
    v_mul_u32_u24 v156, 1040, v51
    v_lshl_add_u32 v156, v50, 4, v156
    v_lshlrev_b32 v51, 8, v51
    v_lshl_add_u32 v157, v50, 4, v51
    v_add_u32 v157, 512, v157
    s_mov_b32 exec_lo, 0xffff0000
    s_mov_b32 exec_hi, 0xffff0000
    v_mov_b32 v157, 0x1000000
    s_mov_b32 exec_lo, 0x00110000
    s_mov_b32 exec_hi, 0x00110000
    v_mov_b32 v157, 1024
    s_mov_b64 exec, -1
    v_mov_b32 v45, 0xff800000
    v_mov_b32 v47, 0xff800000
    s_mov_b32 s49, 0
L_fb_23:
    ds_read_b128 v[12:15], v156
    s_waitcnt lgkmcnt(0)
    v_mfma_f32_32x32x16_bf16 v[64:79], v[12:15], v[4:7], 0
    v_mfma_f32_32x32x16_bf16 v[80:95], v[12:15], v[8:11], 0
    v_add_u32 v156, 2080, v156
    s_nop 15
    v_max3_f32 v45, v45, v64, v65
    v_max3_f32 v45, v45, v66, v67
    v_max3_f32 v45, v45, v68, v69
    v_max3_f32 v45, v45, v70, v71
    v_max3_f32 v45, v45, v72, v73
    v_max3_f32 v45, v45, v74, v75
    v_max3_f32 v45, v45, v76, v77
    v_max3_f32 v45, v45, v78, v79
    v_max3_f32 v47, v47, v80, v81
    v_max3_f32 v47, v47, v82, v83
    v_max3_f32 v47, v47, v84, v85
    v_max3_f32 v47, v47, v86, v87
    v_max3_f32 v47, v47, v88, v89
    v_max3_f32 v47, v47, v90, v91
    v_max3_f32 v47, v47, v92, v93
    v_max3_f32 v47, v47, v94, v95
    s_add_u32 s49, s49, 1
    s_cmp_lt_u32 s49, 64
    s_cbranch_scc1 L_fb_23
    v_and_b32 v50, 31, v0
    v_lshrrev_b32 v51, 5, v0
    v_mul_u32_u24 v156, 1040, v51
    v_lshl_add_u32 v156, v50, 4, v156
    v_lshlrev_b32 v51, 8, v51
    v_lshl_add_u32 v157, v50, 4, v51
    v_add_u32 v157, 512, v157
    s_mov_b32 exec_lo, 0xffff0000
    s_mov_b32 exec_hi, 0xffff0000
    v_mov_b32 v157, 0x1000000
    s_mov_b32 exec_lo, 0x00110000
    s_mov_b32 exec_hi, 0x00110000
    v_mov_b32 v157, 1024
    s_mov_b64 exec, -1
    ds_read_b128 v[12:15], v156
    v_mov_b32 v224, 0
    v_mov_b32 v225, 0
    v_mov_b32 v226, 0
    v_mov_b32 v227, 0
    v_mov_b32 v228, 0
    v_mov_b32 v229, 0
    v_mov_b32 v230, 0
    v_mov_b32 v231, 0
    v_mov_b32 v232, 0
    v_mov_b32 v233, 0
    v_mov_b32 v234, 0
    v_mov_b32 v235, 0
    v_mov_b32 v236, 0
    v_mov_b32 v237, 0
    v_mov_b32 v238, 0
    v_mov_b32 v239, 0
    v_mov_b32 v240, 0
    v_mov_b32 v241, 0
    v_mov_b32 v242, 0
    v_mov_b32 v243, 0
    v_mov_b32 v244, 0
    v_mov_b32 v245, 0
    v_mov_b32 v246, 0
    v_mov_b32 v247, 0
    v_mov_b32 v248, 0
    v_mov_b32 v249, 0
    v_mov_b32 v250, 0
    v_mov_b32 v251, 0
    v_mov_b32 v252, 0
    v_mov_b32 v253, 0
    v_mov_b32 v254, 0
    v_mov_b32 v255, 0
    v_mov_b32 v32, 0
    v_mov_b32 v33, 0
    v_mov_b32 v34, 0
    v_mov_b32 v35, 0
    s_waitcnt lgkmcnt(0)
    s_branch L_restart_11
L_ldkv:
    s_mov_b32 s40, s20
    s_mov_b32 s41, s21
    s_mov_b32 s42, 1024
    s_mov_b32 s43, 0x20000
    s_mov_b32 m0, 159744
    s_add_u32 s55, s55, 1
    buffer_load_dwordx4 v1, s[40:43], 0 offen lds
    s_mov_b32 s40, s6
    s_mov_b32 s41, s7
    s_mov_b32 s42, 524288
    s_mov_b32 s43, 0x20000
    s_and_b32 s55, s55, 7
    s_lshl_b32 s52, s55, 7
    s_lshl_b32 s53, s55, 11
    s_add_u32 m0, s50, 135168
    s_nop 0
    buffer_load_dwordx4 v7, s[44:47], s53 offen lds
    s_add_u32 m0, s49, 16384
    s_nop 0
    buffer_load_dwordx4 v2, s[36:39], s52 offen lds
    s_add_u32 m0, s49, 17408
    s_nop 0
    buffer_load_dwordx4 v3, s[36:39], s52 offen lds
    s_add_u32 m0, s49, 18432
    s_nop 0
    buffer_load_dwordx4 v4, s[36:39], s52 offen lds
    s_add_u32 m0, s49, 19456
    s_nop 0
    buffer_load_dwordx4 v5, s[36:39], s52 offen lds
    s_add_u32 s55, s55, 1
    v_and_b32 v50, 31, v0
    v_lshrrev_b32 v51, 5, v0
    v_mul_u32_u24 v156, 1040, v51
    v_lshl_add_u32 v156, v50, 4, v156
    v_lshlrev_b32 v51, 8, v51
    v_lshl_add_u32 v157, v50, 4, v51
    v_add_u32 v157, 512, v157
    s_mov_b32 exec_lo, 0xffff0000
    s_mov_b32 exec_hi, 0xffff0000
    v_mov_b32 v157, 0x1000000
    s_mov_b32 exec_lo, 0x00110000
    s_mov_b32 exec_hi, 0x00110000
    v_mov_b32 v157, 1024
    s_mov_b64 exec, -1
    v_mov_b32 v224, 0
    v_mov_b32 v225, 0
    v_mov_b32 v226, 0
    v_mov_b32 v227, 0
    v_mov_b32 v228, 0
    v_mov_b32 v229, 0
    v_mov_b32 v230, 0
    v_mov_b32 v231, 0
    v_mov_b32 v232, 0
    v_mov_b32 v233, 0
    v_mov_b32 v234, 0
    v_mov_b32 v235, 0
    v_mov_b32 v236, 0
    v_mov_b32 v237, 0
    v_mov_b32 v238, 0
    v_mov_b32 v239, 0
    v_mov_b32 v240, 0
    v_mov_b32 v241, 0
    v_mov_b32 v242, 0
    v_mov_b32 v243, 0
    v_mov_b32 v244, 0
    v_mov_b32 v245, 0
    v_mov_b32 v246, 0
    v_mov_b32 v247, 0
    v_mov_b32 v248, 0
    v_mov_b32 v249, 0
    v_mov_b32 v250, 0
    v_mov_b32 v251, 0
    v_mov_b32 v252, 0
    v_mov_b32 v253, 0
    v_mov_b32 v254, 0
    v_mov_b32 v255, 0
    v_mov_b32 v32, 0
    v_mov_b32 v33, 0
    v_mov_b32 v34, 0
    v_mov_b32 v35, 0
    s_lshl_b32 s3, s48, 7
    s_add_u32 s3, s3, 162944
    v_lshl_add_u32 v158, v50, 2, s3
    s_mul_i32 s3, s48, 7424
    s_add_u32 s3, s3, 133120
    v_add_u32 v159, s3, v1
    v_mov_b32 v55, 0x1000000
    v_mov_b32 v56, 1
    s_mov_b64 exec, 1
    v_mov_b32 v55, 162816
    s_mov_b64 exec, -1
    v_mov_b32 v54, 0xdddddddd
    v_lshlrev_b32 v15, 2, v0
    v_mov_b32 v20, 1
    v_mov_b32 v19, 0
    s_and_b32 s55, s55, 7
    s_lshl_b32 s52, s55, 7
    s_lshl_b32 s53, s55, 11
    s_add_u32 m0, s50, 139264
    s_nop 0
    buffer_load_dwordx4 v7, s[44:47], s53 offen lds
    s_add_u32 m0, s49, 32768
    s_nop 0
    buffer_load_dwordx4 v2, s[36:39], s52 offen lds
    s_add_u32 m0, s49, 33792
    s_nop 0
    buffer_load_dwordx4 v3, s[36:39], s52 offen lds
    s_add_u32 m0, s49, 34816
    s_nop 0
    buffer_load_dwordx4 v4, s[36:39], s52 offen lds
    s_add_u32 m0, s49, 35840
    s_nop 0
    buffer_load_dwordx4 v5, s[36:39], s52 offen lds
    s_add_u32 s55, s55, 1
    s_waitcnt vmcnt(10)
    s_barrier
    s_and_b32 s55, s55, 7
    s_lshl_b32 s52, s55, 7
    s_lshl_b32 s53, s55, 11
    s_add_u32 m0, s50, 143360
    s_nop 0
    buffer_load_dwordx4 v7, s[44:47], s53 offen lds
    s_add_u32 m0, s49, 49152
    s_nop 0
    buffer_load_dwordx4 v2, s[36:39], s52 offen lds
    s_add_u32 m0, s49, 50176
    s_nop 0
    buffer_load_dwordx4 v3, s[36:39], s52 offen lds
    s_add_u32 m0, s49, 51200
    s_nop 0
    buffer_load_dwordx4 v4, s[36:39], s52 offen lds
    s_add_u32 m0, s49, 52224
    s_nop 0
    buffer_load_dwordx4 v5, s[36:39], s52 offen lds
    s_add_u32 s55, s55, 1
    s_waitcnt vmcnt(10)
    s_barrier
    s_and_b32 s55, s55, 7
    s_lshl_b32 s52, s55, 7
    s_lshl_b32 s53, s55, 11
    s_add_u32 m0, s50, 147456
    s_nop 0
    buffer_load_dwordx4 v7, s[44:47], s53 offen lds
    s_add_u32 m0, s49, 65536
    s_nop 0
    buffer_load_dwordx4 v2, s[36:39], s52 offen lds
    s_add_u32 m0, s49, 66560
    s_nop 0
    buffer_load_dwordx4 v3, s[36:39], s52 offen lds
    s_add_u32 m0, s49, 67584
    s_nop 0
    buffer_load_dwordx4 v4, s[36:39], s52 offen lds
    s_add_u32 m0, s49, 68608
    s_nop 0
    buffer_load_dwordx4 v5, s[36:39], s52 offen lds
    s_add_u32 s55, s55, 1
    s_waitcnt vmcnt(10)
    s_barrier
    s_and_b32 s55, s55, 7
    s_lshl_b32 s52, s55, 7
    s_lshl_b32 s53, s55, 11
    s_add_u32 m0, s50, 151552
    s_nop 0
    buffer_load_dwordx4 v7, s[44:47], s53 offen lds
    s_add_u32 m0, s49, 81920
    s_nop 0
    buffer_load_dwordx4 v2, s[36:39], s52 offen lds
    s_add_u32 m0, s49, 82944
    s_nop 0
    buffer_load_dwordx4 v3, s[36:39], s52 offen lds
    s_add_u32 m0, s49, 83968
    s_nop 0
    buffer_load_dwordx4 v4, s[36:39], s52 offen lds
    s_add_u32 m0, s49, 84992
    s_nop 0
    buffer_load_dwordx4 v5, s[36:39], s52 offen lds
    s_add_u32 s55, s55, 1
    s_waitcnt vmcnt(10)
    s_barrier
    s_and_b32 s55, s55, 7
    s_lshl_b32 s52, s55, 7
    s_lshl_b32 s53, s55, 11
    s_add_u32 m0, s50, 155648
    s_nop 0
    buffer_load_dwordx4 v7, s[44:47], s53 offen lds
    s_add_u32 m0, s49, 98304
    s_nop 0
    buffer_load_dwordx4 v2, s[36:39], s52 offen lds
    s_add_u32 m0, s49, 99328
    s_nop 0
    buffer_load_dwordx4 v3, s[36:39], s52 offen lds
    s_add_u32 m0, s49, 100352
    s_nop 0
    buffer_load_dwordx4 v4, s[36:39], s52 offen lds
    s_add_u32 m0, s49, 101376
    s_nop 0
    buffer_load_dwordx4 v5, s[36:39], s52 offen lds
    s_add_u32 s55, s55, 1
    s_waitcnt vmcnt(10)
    s_barrier
    s_and_b32 s55, s55, 7
    s_lshl_b32 s52, s55, 7
    s_lshl_b32 s53, s55, 11
    s_add_u32 m0, s50, 131072
    s_nop 0
    buffer_load_dwordx4 v7, s[44:47], s53 offen lds
    s_add_u32 m0, s49, 114688
    s_nop 0
    buffer_load_dwordx4 v2, s[36:39], s52 offen lds
    s_add_u32 m0, s49, 115712
    s_nop 0
    buffer_load_dwordx4 v3, s[36:39], s52 offen lds
    s_add_u32 m0, s49, 116736
    s_nop 0
    buffer_load_dwordx4 v4, s[36:39], s52 offen lds
    s_add_u32 m0, s49, 117760
    s_nop 0
    buffer_load_dwordx4 v5, s[36:39], s52 offen lds
    s_add_u32 s55, s55, 1
    s_waitcnt vmcnt(10)
    s_barrier
    s_and_b32 s55, s55, 7
    s_lshl_b32 s53, s55, 16
    s_add_u32 m0, s50, 135168
    s_nop 0
    buffer_load_dwordx4 v6, s[40:43], s53 offen lds
    s_add_u32 s55, s55, 1
    s_and_b32 s55, s55, 7
    s_lshl_b32 s53, s55, 16
    s_add_u32 m0, s50, 139264
    s_nop 0
    buffer_load_dwordx4 v6, s[40:43], s53 offen lds
    s_add_u32 s55, s55, 1
    s_and_b32 s55, s55, 7
    s_lshl_b32 s53, s55, 16
    s_add_u32 m0, s50, 143360
    s_nop 0
    buffer_load_dwordx4 v6, s[40:43], s53 offen lds
    s_add_u32 s55, s55, 1
    s_and_b32 s55, s55, 7
    s_lshl_b32 s53, s55, 16
    s_add_u32 m0, s50, 147456
    s_nop 0
    buffer_load_dwordx4 v6, s[40:43], s53 offen lds
    s_add_u32 s55, s55, 1
    s_waitcnt vmcnt(9)
    s_barrier
    s_waitcnt vmcnt(4)
    s_barrier
    s_waitcnt vmcnt(3)
    s_barrier
    s_waitcnt vmcnt(2)
    s_barrier
    s_waitcnt vmcnt(1)
    s_barrier
    s_and_b32 s55, s55, 7
    s_lshl_b32 s53, s55, 16
    s_add_u32 m0, s50, 151552
    s_nop 0
    buffer_load_dwordx4 v6, s[40:43], s53 offen lds
    s_add_u32 s55, s55, 1
    s_and_b32 s55, s55, 7
    s_lshl_b32 s53, s55, 16
    s_add_u32 m0, s50, 155648
    s_nop 0
    buffer_load_dwordx4 v6, s[40:43], s53 offen lds
    s_add_u32 s55, s55, 1
    s_and_b32 s55, s55, 7
    s_lshl_b32 s53, s55, 16
    s_add_u32 m0, s50, 131072
    s_nop 0
    buffer_load_dwordx4 v6, s[40:43], s53 offen lds
    s_add_u32 s55, s55, 1
    s_and_b32 s55, s55, 7
    s_lshl_b32 s53, s55, 16
    s_add_u32 m0, s50, 135168
    s_nop 0
    buffer_load_dwordx4 v6, s[40:43], s53 offen lds
    s_add_u32 s55, s55, 1
    s_waitcnt vmcnt(4)
    s_barrier
    s_waitcnt vmcnt(3)
    s_barrier
    s_waitcnt vmcnt(2)
    s_barrier
    s_waitcnt vmcnt(1)
    s_barrier
    s_waitcnt vmcnt(0)
    s_barrier
    s_cmp_lg_u32 s48, 0
    s_cbranch_scc1 L_npi_24
    s_mov_b64 exec, 0xffff
    buffer_load_dword v20, v17, s[32:35], s56 offen sc1
    s_mov_b64 exec, -1
L_npi_24:
    s_barrier
    s_branch L_attn
L_cg:
    s_cmp_eq_u32 s48, 0
    s_cbranch_scc0 L_nopf_25
    s_getpc_b64 s[62:63]
L_pc:
    s_sub_u32 s62, s62, L_pc-gated_mix__grouped_kv_mqa__dense_activation_silu__prompt_kernel
    s_subb_u32 s63, s63, 0
    s_lshr_b32 s3, s2, 3
    s_lshl_b32 s3, s3, 10
    v_lshlrev_b32 v2, 7, v0
    v_add_u32 v2, s3, v2
    v_cmp_gt_u32 vcc, 8, v0
    s_mov_b32 s3, L_exit-gated_mix__grouped_kv_mqa__dense_activation_silu__prompt_kernel
    v_cmp_gt_u32 s[54:55], s3, v2
    s_and_b64 vcc, vcc, s[54:55]
    s_and_saveexec_b64 s[54:55], vcc
    s_cbranch_execz L_nopf2
    global_load_dword v250, v2, s[62:63]
L_nopf2:
    s_mov_b64 exec, -1
    v_lshlrev_b32 v2, 2, v0
    v_add_u32 v2, 162816, v2
    v_mov_b32 v3, 0
    ds_write_b32 v2, v3
L_nopf_25:
    v_mov_b32 v244, -1
    v_mov_b32 v245, -1
    v_mov_b32 v246, -1
    v_mov_b32 v247, -1
    s_lshl_b32 s58, s29, 2
    s_add_u32 s58, s58, s48
    s_lshl_b32 s50, s58, 4
    s_add_u32 s50, s50, s30
    s_lshl_b32 s50, s50, 11
    s_add_u32 s50, s50, 3145728
    s_waitcnt lgkmcnt(0)
    s_mov_b32 s32, s26
    s_mov_b32 s33, s27
    s_mov_b32 s34, 67108864
    s_mov_b32 s35, 0x20000
    s_lshl_b32 s3, s48, 4
    s_add_u32 s3, s3, s30
    s_cmp_eq_u32 s3, 15
    s_cbranch_scc0 L_nz_26
    s_lshl_b32 s3, s29, 8
    s_add_u32 s3, s3, 327680
    v_mov_b32 v12, 0
    s_mov_b64 exec, 1
    buffer_store_dword v12, v12, s[32:35], s3 offen sc1
    s_add_u32 s3, s3, 65536
    buffer_load_dword v63, v12, s[32:35], s3 offen sc1
    s_mov_b64 exec, -1
L_nz_26:
    v_lshrrev_b32 v13, 3, v0
    v_and_b32 v14, 7, v0
    v_bfe_u32 v12, v0, 4, 1
    v_lshlrev_b32 v12, 2, v12
    v_xor_b32 v14, v14, v12
    v_lshlrev_b32 v14, 4, v14
    v_lshl_add_u32 v234, v13, 10, v14
    s_lshr_b32 s3, s2, 5
    s_lshl_b32 s3, s3, 7
    v_add_u32 v234, s3, v234
    v_add_u32 v235, 0x2000, v234
    v_lshrrev_b32 v13, 5, v0
    v_bfe_u32 v14, v0, 2, 2
    v_lshl_add_u32 v13, v13, 2, v14
    v_lshlrev_b32 v13, 7, v13
    v_bfe_u32 v14, v0, 3, 1
    v_lshl_add_u32 v13, v14, 6, v13
    v_bfe_u32 v14, v0, 4, 1
    v_lshl_add_u32 v13, v14, 5, v13
    v_and_b32 v14, 3, v0
    v_lshl_add_u32 v13, v14, 3, v13
    s_lshr_b32 s3, s48, 1
    s_lshl_b32 s3, s3, 6
    v_xor_b32 v13, s3, v13
    s_mul_i32 s60, s48, 7424
    s_add_u32 s60, s60, 133120
    v_add_u32 v236, s60, v13
    v_xor_b32 v237, 64, v236
    s_and_b32 s3, s2, 1
    s_lshl_b32 s3, s3, 1
    s_lshl_b32 s59, s29, 2
    s_add_u32 s59, s59, s3
    s_and_b32 s3, s48, 1
    s_add_u32 s59, s59, s3
    s_xor_b32 s3, s59, 0
    s_mul_i32 s3, s3, 86
    s_add_u32 s3, s3, s48
    s_lshl_b32 s3, s3, 10
    s_add_u32 s3, s3, 5242880
    v_add_u32 v232, s3, v1
    s_xor_b32 s3, s59, 1
    s_mul_i32 s3, s3, 86
    s_add_u32 s3, s3, s48
    s_lshl_b32 s3, s3, 10
    s_add_u32 s3, s3, 5242880
    v_add_u32 v233, s3, v1
    v_mov_b32 v238, 0
    v_and_b32 v239, 31, v0
    v_lshlrev_b32 v239, 2, v239
    v_mov_b32 v240, 0x1000000
    v_mov_b32 v241, 1
    s_mov_b64 exec, 1
    v_mov_b32 v240, 162816
    s_mov_b64 exec, -1
    s_lshl_b32 s3, s48, 7
    s_add_u32 s3, s3, 162944
    v_add_u32 v242, s3, v239
    v_add_u32 v243, s60, v1
    s_mov_b32 s57, 0
    v_and_b32 v8, 31, v0
    v_lshrrev_b32 v2, 5, v0
    v_bfe_u32 v3, v8, 1, 3
    v_xor_b32 v3, v3, v2
    v_lshlrev_b32 v3, 4, v3
    s_lshl_b32 s3, s48, 5
    v_add_u32 v8, s3, v8
    v_lshl_add_u32 v3, v8, 7, v3
    v_xor_b32 v52, 0, v3
    v_xor_b32 v53, 32, v3
    v_xor_b32 v54, 64, v3
    v_xor_b32 v55, 96, v3
    v_xor_b32 v56, 0, v3
    v_add_u32 v56, 0x10000, v56
    v_xor_b32 v57, 32, v3
    v_add_u32 v57, 0x10000, v57
    v_xor_b32 v58, 64, v3
    v_add_u32 v58, 0x10000, v58
    v_xor_b32 v59, 96, v3
    v_add_u32 v59, 0x10000, v59
    v_bfe_u32 v8, v0, 2, 2
    v_lshl_add_u32 v8, v2, 3, v8
    v_bfe_u32 v9, v0, 4, 1
    v_and_b32 v10, 3, v0
    v_lshlrev_b32 v10, 3, v10
    v_lshl_add_u32 v11, v9, 5, v10
    s_mov_b32 s54, 0x3eb8aa3b
    s_mov_b32 s55, 0x3eb8aa3b
    s_cmp_eq_u32 s30, 15
    s_cbranch_scc1 L_compkv
    v_lshl_add_u32 v60, v8, 6, v11
    v_add_u32 v61, 0x10000, v60
    v_mul_u32_u24 v62, 192, v8
    v_add_u32 v62, v62, v11
    v_add_u32 v63, 0x10000, v62
    s_barrier
    ds_read_b128 v[12:15], v52 offset:0
    ds_read_b64_tr_b16 v[20:21], v60 offset:16384
    ds_read_b64_tr_b16 v[22:23], v60 offset:16640
    ds_read_b64_tr_b16 v[24:25], v62 offset:20480
    ds_read_b64_tr_b16 v[26:27], v62 offset:21248
    ds_read_b64_tr_b16 v[28:29], v62 offset:20544
    ds_read_b64_tr_b16 v[30:31], v62 offset:21312
    ds_read_b64_tr_b16 v[32:33], v62 offset:20608
    ds_read_b64_tr_b16 v[34:35], v62 offset:21376
    s_waitcnt lgkmcnt(6)
    v_mfma_f32_32x32x16_bf16 v[64:79], v[20:23], v[12:15], 0
    ds_read_b128 v[16:19], v53 offset:0
    ds_read_b64_tr_b16 v[36:37], v60 offset:17408
    ds_read_b64_tr_b16 v[38:39], v60 offset:17664
    ds_read_b64_tr_b16 v[40:41], v62 offset:23552
    ds_read_b64_tr_b16 v[42:43], v62 offset:24320
    s_waitcnt lgkmcnt(9)
    v_mfma_f32_32x32x16_bf16 v[80:95], v[24:27], v[12:15], 0
    ds_read_b64_tr_b16 v[44:45], v62 offset:23616
    ds_read_b64_tr_b16 v[46:47], v62 offset:24384
    ds_read_b64_tr_b16 v[48:49], v62 offset:23680
    ds_read_b64_tr_b16 v[50:51], v62 offset:24448
    s_waitcnt lgkmcnt(11)
    v_mfma_f32_32x32x16_bf16 v[96:111], v[28:31], v[12:15], 0
    s_waitcnt lgkmcnt(9)
    v_mfma_f32_32x32x16_bf16 v[112:127], v[32:35], v[12:15], 0
    s_waitcnt lgkmcnt(6)
    v_mfma_f32_32x32x16_bf16 v[64:79], v[36:39], v[16:19], v[64:79]
    ds_read_b128 v[12:15], v54 offset:0
    ds_read_b64_tr_b16 v[20:21], v60 offset:18432
    ds_read_b64_tr_b16 v[22:23], v60 offset:18688
    ds_read_b64_tr_b16 v[24:25], v62 offset:26624
    ds_read_b64_tr_b16 v[26:27], v62 offset:27392
    s_waitcnt lgkmcnt(9)
    v_mfma_f32_32x32x16_bf16 v[80:95], v[40:43], v[16:19], v[80:95]
    ds_read_b64_tr_b16 v[28:29], v62 offset:26688
    ds_read_b64_tr_b16 v[30:31], v62 offset:27456
    ds_read_b64_tr_b16 v[32:33], v62 offset:26752
    ds_read_b64_tr_b16 v[34:35], v62 offset:27520
    s_waitcnt lgkmcnt(11)
    v_mfma_f32_32x32x16_bf16 v[96:111], v[44:47], v[16:19], v[96:111]
    s_waitcnt lgkmcnt(9)
    v_mfma_f32_32x32x16_bf16 v[112:127], v[48:51], v[16:19], v[112:127]
    s_waitcnt lgkmcnt(6)
    v_mfma_f32_32x32x16_bf16 v[64:79], v[20:23], v[12:15], v[64:79]
    ds_read_b128 v[16:19], v55 offset:0
    ds_read_b64_tr_b16 v[36:37], v60 offset:19456
    ds_read_b64_tr_b16 v[38:39], v60 offset:19712
    ds_read_b64_tr_b16 v[40:41], v62 offset:29696
    ds_read_b64_tr_b16 v[42:43], v62 offset:30464
    s_waitcnt lgkmcnt(9)
    v_mfma_f32_32x32x16_bf16 v[80:95], v[24:27], v[12:15], v[80:95]
    ds_read_b64_tr_b16 v[44:45], v62 offset:29760
    ds_read_b64_tr_b16 v[46:47], v62 offset:30528
    ds_read_b64_tr_b16 v[48:49], v62 offset:29824
    ds_read_b64_tr_b16 v[50:51], v62 offset:30592
    s_waitcnt lgkmcnt(11)
    v_mfma_f32_32x32x16_bf16 v[96:111], v[28:31], v[12:15], v[96:111]
    s_waitcnt lgkmcnt(9)
    v_mfma_f32_32x32x16_bf16 v[112:127], v[32:35], v[12:15], v[112:127]
    s_waitcnt lgkmcnt(0)
    s_barrier
    v_mfma_f32_32x32x16_bf16 v[64:79], v[36:39], v[16:19], v[64:79]
    ds_read_b128 v[12:15], v52 offset:32768
    ds_read_b64_tr_b16 v[20:21], v60 offset:49152
    ds_read_b64_tr_b16 v[22:23], v60 offset:49408
    ds_read_b64_tr_b16 v[24:25], v62 offset:53248
    ds_read_b64_tr_b16 v[26:27], v62 offset:54016
    v_mfma_f32_32x32x16_bf16 v[80:95], v[40:43], v[16:19], v[80:95]
    ds_read_b64_tr_b16 v[28:29], v62 offset:53312
    ds_read_b64_tr_b16 v[30:31], v62 offset:54080
    ds_read_b64_tr_b16 v[32:33], v62 offset:53376
    ds_read_b64_tr_b16 v[34:35], v62 offset:54144
    v_mfma_f32_32x32x16_bf16 v[96:111], v[44:47], v[16:19], v[96:111]
    v_mfma_f32_32x32x16_bf16 v[112:127], v[48:51], v[16:19], v[112:127]
    s_waitcnt lgkmcnt(6)
    v_mfma_f32_32x32x16_bf16 v[64:79], v[20:23], v[12:15], v[64:79]
    ds_read_b128 v[16:19], v53 offset:32768
    ds_read_b64_tr_b16 v[36:37], v60 offset:50176
    ds_read_b64_tr_b16 v[38:39], v60 offset:50432
    ds_read_b64_tr_b16 v[40:41], v62 offset:56320
    ds_read_b64_tr_b16 v[42:43], v62 offset:57088
    s_waitcnt lgkmcnt(9)
    v_mfma_f32_32x32x16_bf16 v[80:95], v[24:27], v[12:15], v[80:95]
    ds_read_b64_tr_b16 v[44:45], v62 offset:56384
    ds_read_b64_tr_b16 v[46:47], v62 offset:57152
    ds_read_b64_tr_b16 v[48:49], v62 offset:56448
    ds_read_b64_tr_b16 v[50:51], v62 offset:57216
    s_waitcnt lgkmcnt(11)
    v_mfma_f32_32x32x16_bf16 v[96:111], v[28:31], v[12:15], v[96:111]
    s_waitcnt lgkmcnt(9)
    v_mfma_f32_32x32x16_bf16 v[112:127], v[32:35], v[12:15], v[112:127]
    s_waitcnt lgkmcnt(6)
    v_mfma_f32_32x32x16_bf16 v[64:79], v[36:39], v[16:19], v[64:79]
    ds_read_b128 v[12:15], v54 offset:32768
    ds_read_b64_tr_b16 v[20:21], v60 offset:51200
    ds_read_b64_tr_b16 v[22:23], v60 offset:51456
    ds_read_b64_tr_b16 v[24:25], v62 offset:59392
    ds_read_b64_tr_b16 v[26:27], v62 offset:60160
    s_waitcnt lgkmcnt(9)
    v_mfma_f32_32x32x16_bf16 v[80:95], v[40:43], v[16:19], v[80:95]
    ds_read_b64_tr_b16 v[28:29], v62 offset:59456
    ds_read_b64_tr_b16 v[30:31], v62 offset:60224
    ds_read_b64_tr_b16 v[32:33], v62 offset:59520
    ds_read_b64_tr_b16 v[34:35], v62 offset:60288
    s_waitcnt lgkmcnt(11)
    v_mfma_f32_32x32x16_bf16 v[96:111], v[44:47], v[16:19], v[96:111]
    s_waitcnt lgkmcnt(9)
    v_mfma_f32_32x32x16_bf16 v[112:127], v[48:51], v[16:19], v[112:127]
    s_waitcnt lgkmcnt(6)
    v_mfma_f32_32x32x16_bf16 v[64:79], v[20:23], v[12:15], v[64:79]
    ds_read_b128 v[16:19], v55 offset:32768
    ds_read_b64_tr_b16 v[36:37], v60 offset:52224
    ds_read_b64_tr_b16 v[38:39], v60 offset:52480
    ds_read_b64_tr_b16 v[40:41], v62 offset:62464
    ds_read_b64_tr_b16 v[42:43], v62 offset:63232
    s_waitcnt lgkmcnt(9)
    v_mfma_f32_32x32x16_bf16 v[80:95], v[24:27], v[12:15], v[80:95]
    ds_read_b64_tr_b16 v[44:45], v62 offset:62528
    ds_read_b64_tr_b16 v[46:47], v62 offset:63296
    ds_read_b64_tr_b16 v[48:49], v62 offset:62592
    ds_read_b64_tr_b16 v[50:51], v62 offset:63360
    s_waitcnt lgkmcnt(11)
    v_mfma_f32_32x32x16_bf16 v[96:111], v[28:31], v[12:15], v[96:111]
    s_waitcnt lgkmcnt(9)
    v_mfma_f32_32x32x16_bf16 v[112:127], v[32:35], v[12:15], v[112:127]
    s_waitcnt lgkmcnt(0)
    s_barrier
    v_mfma_f32_32x32x16_bf16 v[64:79], v[36:39], v[16:19], v[64:79]
    ds_read_b128 v[12:15], v56 offset:0
    ds_read_b64_tr_b16 v[20:21], v61 offset:16384
    ds_read_b64_tr_b16 v[22:23], v61 offset:16640
    ds_read_b64_tr_b16 v[24:25], v63 offset:20480
    ds_read_b64_tr_b16 v[26:27], v63 offset:21248
    v_mfma_f32_32x32x16_bf16 v[80:95], v[40:43], v[16:19], v[80:95]
    ds_read_b64_tr_b16 v[28:29], v63 offset:20544
    ds_read_b64_tr_b16 v[30:31], v63 offset:21312
    ds_read_b64_tr_b16 v[32:33], v63 offset:20608
    ds_read_b64_tr_b16 v[34:35], v63 offset:21376
    v_mfma_f32_32x32x16_bf16 v[96:111], v[44:47], v[16:19], v[96:111]
    v_mfma_f32_32x32x16_bf16 v[112:127], v[48:51], v[16:19], v[112:127]
    s_waitcnt lgkmcnt(6)
    v_mfma_f32_32x32x16_bf16 v[64:79], v[20:23], v[12:15], v[64:79]
    ds_read_b128 v[16:19], v57 offset:0
    ds_read_b64_tr_b16 v[36:37], v61 offset:17408
    ds_read_b64_tr_b16 v[38:39], v61 offset:17664
    ds_read_b64_tr_b16 v[40:41], v63 offset:23552
    ds_read_b64_tr_b16 v[42:43], v63 offset:24320
    s_waitcnt lgkmcnt(9)
    v_mfma_f32_32x32x16_bf16 v[80:95], v[24:27], v[12:15], v[80:95]
    ds_read_b64_tr_b16 v[44:45], v63 offset:23616
    ds_read_b64_tr_b16 v[46:47], v63 offset:24384
    ds_read_b64_tr_b16 v[48:49], v63 offset:23680
    ds_read_b64_tr_b16 v[50:51], v63 offset:24448
    s_waitcnt lgkmcnt(11)
    v_mfma_f32_32x32x16_bf16 v[96:111], v[28:31], v[12:15], v[96:111]
    s_waitcnt lgkmcnt(9)
    v_mfma_f32_32x32x16_bf16 v[112:127], v[32:35], v[12:15], v[112:127]
    s_waitcnt lgkmcnt(6)
    v_mfma_f32_32x32x16_bf16 v[64:79], v[36:39], v[16:19], v[64:79]
    ds_read_b128 v[12:15], v58 offset:0
    ds_read_b64_tr_b16 v[20:21], v61 offset:18432
    ds_read_b64_tr_b16 v[22:23], v61 offset:18688
    ds_read_b64_tr_b16 v[24:25], v63 offset:26624
    ds_read_b64_tr_b16 v[26:27], v63 offset:27392
    s_waitcnt lgkmcnt(9)
    v_mfma_f32_32x32x16_bf16 v[80:95], v[40:43], v[16:19], v[80:95]
    ds_read_b64_tr_b16 v[28:29], v63 offset:26688
    ds_read_b64_tr_b16 v[30:31], v63 offset:27456
    ds_read_b64_tr_b16 v[32:33], v63 offset:26752
    ds_read_b64_tr_b16 v[34:35], v63 offset:27520
    s_waitcnt lgkmcnt(11)
    v_mfma_f32_32x32x16_bf16 v[96:111], v[44:47], v[16:19], v[96:111]
    s_waitcnt lgkmcnt(9)
    v_mfma_f32_32x32x16_bf16 v[112:127], v[48:51], v[16:19], v[112:127]
    s_waitcnt lgkmcnt(6)
    v_mfma_f32_32x32x16_bf16 v[64:79], v[20:23], v[12:15], v[64:79]
    ds_read_b128 v[16:19], v59 offset:0
    ds_read_b64_tr_b16 v[36:37], v61 offset:19456
    ds_read_b64_tr_b16 v[38:39], v61 offset:19712
    ds_read_b64_tr_b16 v[40:41], v63 offset:29696
    ds_read_b64_tr_b16 v[42:43], v63 offset:30464
    s_waitcnt lgkmcnt(9)
    v_mfma_f32_32x32x16_bf16 v[80:95], v[24:27], v[12:15], v[80:95]
    ds_read_b64_tr_b16 v[44:45], v63 offset:29760
    ds_read_b64_tr_b16 v[46:47], v63 offset:30528
    ds_read_b64_tr_b16 v[48:49], v63 offset:29824
    ds_read_b64_tr_b16 v[50:51], v63 offset:30592
    s_waitcnt lgkmcnt(11)
    v_mfma_f32_32x32x16_bf16 v[96:111], v[28:31], v[12:15], v[96:111]
    s_waitcnt lgkmcnt(9)
    v_mfma_f32_32x32x16_bf16 v[112:127], v[32:35], v[12:15], v[112:127]
    s_waitcnt lgkmcnt(0)
    s_barrier
    v_mfma_f32_32x32x16_bf16 v[64:79], v[36:39], v[16:19], v[64:79]
    ds_read_b128 v[12:15], v56 offset:32768
    ds_read_b64_tr_b16 v[20:21], v61 offset:49152
    ds_read_b64_tr_b16 v[22:23], v61 offset:49408
    ds_read_b64_tr_b16 v[24:25], v63 offset:53248
    ds_read_b64_tr_b16 v[26:27], v63 offset:54016
    v_mfma_f32_32x32x16_bf16 v[80:95], v[40:43], v[16:19], v[80:95]
    ds_read_b64_tr_b16 v[28:29], v63 offset:53312
    ds_read_b64_tr_b16 v[30:31], v63 offset:54080
    ds_read_b64_tr_b16 v[32:33], v63 offset:53376
    ds_read_b64_tr_b16 v[34:35], v63 offset:54144
    v_mfma_f32_32x32x16_bf16 v[96:111], v[44:47], v[16:19], v[96:111]
    v_mfma_f32_32x32x16_bf16 v[112:127], v[48:51], v[16:19], v[112:127]
    s_waitcnt lgkmcnt(6)
    v_mfma_f32_32x32x16_bf16 v[64:79], v[20:23], v[12:15], v[64:79]
    ds_read_b128 v[16:19], v57 offset:32768
    ds_read_b64_tr_b16 v[36:37], v61 offset:50176
    ds_read_b64_tr_b16 v[38:39], v61 offset:50432
    ds_read_b64_tr_b16 v[40:41], v63 offset:56320
    ds_read_b64_tr_b16 v[42:43], v63 offset:57088
    s_waitcnt lgkmcnt(9)
    v_mfma_f32_32x32x16_bf16 v[80:95], v[24:27], v[12:15], v[80:95]
    ds_read_b64_tr_b16 v[44:45], v63 offset:56384
    ds_read_b64_tr_b16 v[46:47], v63 offset:57152
    ds_read_b64_tr_b16 v[48:49], v63 offset:56448
    ds_read_b64_tr_b16 v[50:51], v63 offset:57216
    s_waitcnt lgkmcnt(11)
    v_mfma_f32_32x32x16_bf16 v[96:111], v[28:31], v[12:15], v[96:111]
    s_waitcnt lgkmcnt(9)
    v_mfma_f32_32x32x16_bf16 v[112:127], v[32:35], v[12:15], v[112:127]
    s_waitcnt lgkmcnt(6)
    v_mfma_f32_32x32x16_bf16 v[64:79], v[36:39], v[16:19], v[64:79]
    ds_read_b128 v[12:15], v58 offset:32768
    ds_read_b64_tr_b16 v[20:21], v61 offset:51200
    ds_read_b64_tr_b16 v[22:23], v61 offset:51456
    ds_read_b64_tr_b16 v[24:25], v63 offset:59392
    ds_read_b64_tr_b16 v[26:27], v63 offset:60160
    s_waitcnt lgkmcnt(9)
    v_mfma_f32_32x32x16_bf16 v[80:95], v[40:43], v[16:19], v[80:95]
    ds_read_b64_tr_b16 v[28:29], v63 offset:59456
    ds_read_b64_tr_b16 v[30:31], v63 offset:60224
    ds_read_b64_tr_b16 v[32:33], v63 offset:59520
    ds_read_b64_tr_b16 v[34:35], v63 offset:60288
    s_waitcnt lgkmcnt(11)
    v_mfma_f32_32x32x16_bf16 v[96:111], v[44:47], v[16:19], v[96:111]
    s_waitcnt lgkmcnt(9)
    v_mfma_f32_32x32x16_bf16 v[112:127], v[48:51], v[16:19], v[112:127]
    s_waitcnt lgkmcnt(6)
    v_mfma_f32_32x32x16_bf16 v[64:79], v[20:23], v[12:15], v[64:79]
    ds_read_b128 v[16:19], v59 offset:32768
    ds_read_b64_tr_b16 v[36:37], v61 offset:52224
    ds_read_b64_tr_b16 v[38:39], v61 offset:52480
    ds_read_b64_tr_b16 v[40:41], v63 offset:62464
    ds_read_b64_tr_b16 v[42:43], v63 offset:63232
    s_waitcnt lgkmcnt(9)
    v_mfma_f32_32x32x16_bf16 v[80:95], v[24:27], v[12:15], v[80:95]
    ds_read_b64_tr_b16 v[44:45], v63 offset:62528
    ds_read_b64_tr_b16 v[46:47], v63 offset:63296
    ds_read_b64_tr_b16 v[48:49], v63 offset:62592
    ds_read_b64_tr_b16 v[50:51], v63 offset:63360
    s_waitcnt lgkmcnt(11)
    v_mfma_f32_32x32x16_bf16 v[96:111], v[28:31], v[12:15], v[96:111]
    s_waitcnt lgkmcnt(9)
    v_mfma_f32_32x32x16_bf16 v[112:127], v[32:35], v[12:15], v[112:127]
    s_waitcnt lgkmcnt(0)
    s_barrier
    v_mfma_f32_32x32x16_bf16 v[64:79], v[36:39], v[16:19], v[64:79]
    ds_read_b128 v[12:15], v52 offset:0
    ds_read_b64_tr_b16 v[20:21], v60 offset:16384
    ds_read_b64_tr_b16 v[22:23], v60 offset:16640
    ds_read_b64_tr_b16 v[24:25], v62 offset:20480
    ds_read_b64_tr_b16 v[26:27], v62 offset:21248
    v_mfma_f32_32x32x16_bf16 v[80:95], v[40:43], v[16:19], v[80:95]
    ds_read_b64_tr_b16 v[28:29], v62 offset:20544
    ds_read_b64_tr_b16 v[30:31], v62 offset:21312
    ds_read_b64_tr_b16 v[32:33], v62 offset:20608
    ds_read_b64_tr_b16 v[34:35], v62 offset:21376
    v_mfma_f32_32x32x16_bf16 v[96:111], v[44:47], v[16:19], v[96:111]
    v_mfma_f32_32x32x16_bf16 v[112:127], v[48:51], v[16:19], v[112:127]
    s_waitcnt lgkmcnt(6)
    v_mfma_f32_32x32x16_bf16 v[64:79], v[20:23], v[12:15], v[64:79]
    ds_read_b128 v[16:19], v53 offset:0
    ds_read_b64_tr_b16 v[36:37], v60 offset:17408
    ds_read_b64_tr_b16 v[38:39], v60 offset:17664
    ds_read_b64_tr_b16 v[40:41], v62 offset:23552
    ds_read_b64_tr_b16 v[42:43], v62 offset:24320
    s_waitcnt lgkmcnt(9)
    v_mfma_f32_32x32x16_bf16 v[80:95], v[24:27], v[12:15], v[80:95]
    ds_read_b64_tr_b16 v[44:45], v62 offset:23616
    ds_read_b64_tr_b16 v[46:47], v62 offset:24384
    ds_read_b64_tr_b16 v[48:49], v62 offset:23680
    ds_read_b64_tr_b16 v[50:51], v62 offset:24448
    s_waitcnt lgkmcnt(11)
    v_mfma_f32_32x32x16_bf16 v[96:111], v[28:31], v[12:15], v[96:111]
    s_waitcnt lgkmcnt(9)
    v_mfma_f32_32x32x16_bf16 v[112:127], v[32:35], v[12:15], v[112:127]
    s_waitcnt lgkmcnt(6)
    v_mfma_f32_32x32x16_bf16 v[64:79], v[36:39], v[16:19], v[64:79]
    ds_read_b128 v[12:15], v54 offset:0
    ds_read_b64_tr_b16 v[20:21], v60 offset:18432
    ds_read_b64_tr_b16 v[22:23], v60 offset:18688
    ds_read_b64_tr_b16 v[24:25], v62 offset:26624
    ds_read_b64_tr_b16 v[26:27], v62 offset:27392
    s_waitcnt lgkmcnt(9)
    v_mfma_f32_32x32x16_bf16 v[80:95], v[40:43], v[16:19], v[80:95]
    ds_read_b64_tr_b16 v[28:29], v62 offset:26688
    ds_read_b64_tr_b16 v[30:31], v62 offset:27456
    ds_read_b64_tr_b16 v[32:33], v62 offset:26752
    ds_read_b64_tr_b16 v[34:35], v62 offset:27520
    s_waitcnt lgkmcnt(11)
    v_mfma_f32_32x32x16_bf16 v[96:111], v[44:47], v[16:19], v[96:111]
    s_waitcnt lgkmcnt(9)
    v_mfma_f32_32x32x16_bf16 v[112:127], v[48:51], v[16:19], v[112:127]
    s_waitcnt lgkmcnt(6)
    v_mfma_f32_32x32x16_bf16 v[64:79], v[20:23], v[12:15], v[64:79]
    ds_read_b128 v[16:19], v55 offset:0
    ds_read_b64_tr_b16 v[36:37], v60 offset:19456
    ds_read_b64_tr_b16 v[38:39], v60 offset:19712
    ds_read_b64_tr_b16 v[40:41], v62 offset:29696
    ds_read_b64_tr_b16 v[42:43], v62 offset:30464
    s_waitcnt lgkmcnt(9)
    v_mfma_f32_32x32x16_bf16 v[80:95], v[24:27], v[12:15], v[80:95]
    ds_read_b64_tr_b16 v[44:45], v62 offset:29760
    ds_read_b64_tr_b16 v[46:47], v62 offset:30528
    ds_read_b64_tr_b16 v[48:49], v62 offset:29824
    ds_read_b64_tr_b16 v[50:51], v62 offset:30592
    s_waitcnt lgkmcnt(11)
    v_mfma_f32_32x32x16_bf16 v[96:111], v[28:31], v[12:15], v[96:111]
    s_waitcnt lgkmcnt(9)
    v_mfma_f32_32x32x16_bf16 v[112:127], v[32:35], v[12:15], v[112:127]
    s_waitcnt lgkmcnt(0)
    s_barrier
    v_mfma_f32_32x32x16_bf16 v[64:79], v[36:39], v[16:19], v[64:79]
    ds_read_b128 v[12:15], v52 offset:32768
    ds_read_b64_tr_b16 v[20:21], v60 offset:49152
    ds_read_b64_tr_b16 v[22:23], v60 offset:49408
    ds_read_b64_tr_b16 v[24:25], v62 offset:53248
    ds_read_b64_tr_b16 v[26:27], v62 offset:54016
    v_mfma_f32_32x32x16_bf16 v[80:95], v[40:43], v[16:19], v[80:95]
    ds_read_b64_tr_b16 v[28:29], v62 offset:53312
    ds_read_b64_tr_b16 v[30:31], v62 offset:54080
    ds_read_b64_tr_b16 v[32:33], v62 offset:53376
    ds_read_b64_tr_b16 v[34:35], v62 offset:54144
    v_mfma_f32_32x32x16_bf16 v[96:111], v[44:47], v[16:19], v[96:111]
    v_mfma_f32_32x32x16_bf16 v[112:127], v[48:51], v[16:19], v[112:127]
    s_waitcnt lgkmcnt(6)
    v_mfma_f32_32x32x16_bf16 v[64:79], v[20:23], v[12:15], v[64:79]
    ds_read_b128 v[16:19], v53 offset:32768
    ds_read_b64_tr_b16 v[36:37], v60 offset:50176
    ds_read_b64_tr_b16 v[38:39], v60 offset:50432
    ds_read_b64_tr_b16 v[40:41], v62 offset:56320
    ds_read_b64_tr_b16 v[42:43], v62 offset:57088
    s_waitcnt lgkmcnt(9)
    v_mfma_f32_32x32x16_bf16 v[80:95], v[24:27], v[12:15], v[80:95]
    ds_read_b64_tr_b16 v[44:45], v62 offset:56384
    ds_read_b64_tr_b16 v[46:47], v62 offset:57152
    ds_read_b64_tr_b16 v[48:49], v62 offset:56448
    ds_read_b64_tr_b16 v[50:51], v62 offset:57216
    s_waitcnt lgkmcnt(11)
    v_mfma_f32_32x32x16_bf16 v[96:111], v[28:31], v[12:15], v[96:111]
    s_waitcnt lgkmcnt(9)
    v_mfma_f32_32x32x16_bf16 v[112:127], v[32:35], v[12:15], v[112:127]
    s_waitcnt lgkmcnt(6)
    v_mfma_f32_32x32x16_bf16 v[64:79], v[36:39], v[16:19], v[64:79]
    ds_read_b128 v[12:15], v54 offset:32768
    ds_read_b64_tr_b16 v[20:21], v60 offset:51200
    ds_read_b64_tr_b16 v[22:23], v60 offset:51456
    ds_read_b64_tr_b16 v[24:25], v62 offset:59392
    ds_read_b64_tr_b16 v[26:27], v62 offset:60160
    s_waitcnt lgkmcnt(9)
    v_mfma_f32_32x32x16_bf16 v[80:95], v[40:43], v[16:19], v[80:95]
    ds_read_b64_tr_b16 v[28:29], v62 offset:59456
    ds_read_b64_tr_b16 v[30:31], v62 offset:60224
    ds_read_b64_tr_b16 v[32:33], v62 offset:59520
    ds_read_b64_tr_b16 v[34:35], v62 offset:60288
    s_waitcnt lgkmcnt(11)
    v_mfma_f32_32x32x16_bf16 v[96:111], v[44:47], v[16:19], v[96:111]
    s_waitcnt lgkmcnt(9)
    v_mfma_f32_32x32x16_bf16 v[112:127], v[48:51], v[16:19], v[112:127]
    s_waitcnt lgkmcnt(6)
    v_mfma_f32_32x32x16_bf16 v[64:79], v[20:23], v[12:15], v[64:79]
    ds_read_b128 v[16:19], v55 offset:32768
    ds_read_b64_tr_b16 v[36:37], v60 offset:52224
    ds_read_b64_tr_b16 v[38:39], v60 offset:52480
    ds_read_b64_tr_b16 v[40:41], v62 offset:62464
    ds_read_b64_tr_b16 v[42:43], v62 offset:63232
    s_waitcnt lgkmcnt(9)
    v_mfma_f32_32x32x16_bf16 v[80:95], v[24:27], v[12:15], v[80:95]
    ds_read_b64_tr_b16 v[44:45], v62 offset:62528
    ds_read_b64_tr_b16 v[46:47], v62 offset:63296
    ds_read_b64_tr_b16 v[48:49], v62 offset:62592
    ds_read_b64_tr_b16 v[50:51], v62 offset:63360
    s_waitcnt lgkmcnt(11)
    v_mfma_f32_32x32x16_bf16 v[96:111], v[28:31], v[12:15], v[96:111]
    s_waitcnt lgkmcnt(9)
    v_mfma_f32_32x32x16_bf16 v[112:127], v[32:35], v[12:15], v[112:127]
    s_waitcnt lgkmcnt(0)
    s_barrier
    v_mfma_f32_32x32x16_bf16 v[64:79], v[36:39], v[16:19], v[64:79]
    ds_read_b128 v[12:15], v56 offset:0
    ds_read_b64_tr_b16 v[20:21], v61 offset:16384
    ds_read_b64_tr_b16 v[22:23], v61 offset:16640
    ds_read_b64_tr_b16 v[24:25], v63 offset:20480
    ds_read_b64_tr_b16 v[26:27], v63 offset:21248
    v_mfma_f32_32x32x16_bf16 v[80:95], v[40:43], v[16:19], v[80:95]
    ds_read_b64_tr_b16 v[28:29], v63 offset:20544
    ds_read_b64_tr_b16 v[30:31], v63 offset:21312
    ds_read_b64_tr_b16 v[32:33], v63 offset:20608
    ds_read_b64_tr_b16 v[34:35], v63 offset:21376
    v_mfma_f32_32x32x16_bf16 v[96:111], v[44:47], v[16:19], v[96:111]
    v_mfma_f32_32x32x16_bf16 v[112:127], v[48:51], v[16:19], v[112:127]
    s_waitcnt lgkmcnt(6)
    v_mfma_f32_32x32x16_bf16 v[64:79], v[20:23], v[12:15], v[64:79]
    ds_read_b128 v[16:19], v57 offset:0
    ds_read_b64_tr_b16 v[36:37], v61 offset:17408
    ds_read_b64_tr_b16 v[38:39], v61 offset:17664
    ds_read_b64_tr_b16 v[40:41], v63 offset:23552
    ds_read_b64_tr_b16 v[42:43], v63 offset:24320
    s_waitcnt lgkmcnt(9)
    v_mfma_f32_32x32x16_bf16 v[80:95], v[24:27], v[12:15], v[80:95]
    ds_read_b64_tr_b16 v[44:45], v63 offset:23616
    ds_read_b64_tr_b16 v[46:47], v63 offset:24384
    ds_read_b64_tr_b16 v[48:49], v63 offset:23680
    ds_read_b64_tr_b16 v[50:51], v63 offset:24448
    s_waitcnt lgkmcnt(11)
    v_mfma_f32_32x32x16_bf16 v[96:111], v[28:31], v[12:15], v[96:111]
    s_waitcnt lgkmcnt(9)
    v_mfma_f32_32x32x16_bf16 v[112:127], v[32:35], v[12:15], v[112:127]
    s_waitcnt lgkmcnt(6)
    v_mfma_f32_32x32x16_bf16 v[64:79], v[36:39], v[16:19], v[64:79]
    ds_read_b128 v[12:15], v58 offset:0
    ds_read_b64_tr_b16 v[20:21], v61 offset:18432
    ds_read_b64_tr_b16 v[22:23], v61 offset:18688
    ds_read_b64_tr_b16 v[24:25], v63 offset:26624
    ds_read_b64_tr_b16 v[26:27], v63 offset:27392
    s_waitcnt lgkmcnt(9)
    v_mfma_f32_32x32x16_bf16 v[80:95], v[40:43], v[16:19], v[80:95]
    ds_read_b64_tr_b16 v[28:29], v63 offset:26688
    ds_read_b64_tr_b16 v[30:31], v63 offset:27456
    ds_read_b64_tr_b16 v[32:33], v63 offset:26752
    ds_read_b64_tr_b16 v[34:35], v63 offset:27520
    s_waitcnt lgkmcnt(11)
    v_mfma_f32_32x32x16_bf16 v[96:111], v[44:47], v[16:19], v[96:111]
    s_waitcnt lgkmcnt(9)
    v_mfma_f32_32x32x16_bf16 v[112:127], v[48:51], v[16:19], v[112:127]
    s_waitcnt lgkmcnt(6)
    v_mfma_f32_32x32x16_bf16 v[64:79], v[20:23], v[12:15], v[64:79]
    ds_read_b128 v[16:19], v59 offset:0
    ds_read_b64_tr_b16 v[36:37], v61 offset:19456
    ds_read_b64_tr_b16 v[38:39], v61 offset:19712
    ds_read_b64_tr_b16 v[40:41], v63 offset:29696
    ds_read_b64_tr_b16 v[42:43], v63 offset:30464
    s_waitcnt lgkmcnt(9)
    v_mfma_f32_32x32x16_bf16 v[80:95], v[24:27], v[12:15], v[80:95]
    ds_read_b64_tr_b16 v[44:45], v63 offset:29760
    ds_read_b64_tr_b16 v[46:47], v63 offset:30528
    ds_read_b64_tr_b16 v[48:49], v63 offset:29824
    ds_read_b64_tr_b16 v[50:51], v63 offset:30592
    s_waitcnt lgkmcnt(11)
    v_mfma_f32_32x32x16_bf16 v[96:111], v[28:31], v[12:15], v[96:111]
    s_waitcnt lgkmcnt(9)
    v_mfma_f32_32x32x16_bf16 v[112:127], v[32:35], v[12:15], v[112:127]
    s_waitcnt lgkmcnt(0)
    s_barrier
    v_mfma_f32_32x32x16_bf16 v[64:79], v[36:39], v[16:19], v[64:79]
    ds_read_b128 v[128:131], v56 offset:32768
    ds_read_b64_tr_b16 v[144:145], v61 offset:49152
    ds_read_b64_tr_b16 v[146:147], v61 offset:49408
    ds_read_b128 v[132:135], v57 offset:32768
    ds_read_b64_tr_b16 v[148:149], v61 offset:50176
    ds_read_b64_tr_b16 v[150:151], v61 offset:50432
    v_mfma_f32_32x32x16_bf16 v[80:95], v[40:43], v[16:19], v[80:95]
    ds_read_b128 v[136:139], v58 offset:32768
    ds_read_b64_tr_b16 v[152:153], v61 offset:51200
    ds_read_b64_tr_b16 v[154:155], v61 offset:51456
    ds_read_b128 v[140:143], v59 offset:32768
    ds_read_b64_tr_b16 v[156:157], v61 offset:52224
    ds_read_b64_tr_b16 v[158:159], v61 offset:52480
    v_mfma_f32_32x32x16_bf16 v[96:111], v[44:47], v[16:19], v[96:111]
    v_mfma_f32_32x32x16_bf16 v[112:127], v[48:51], v[16:19], v[112:127]
    s_mov_b32 s54, 0xbfb8aa3b
    s_mov_b32 s55, 0xbfb8aa3b
    s_mov_b32 s62, 1.0
    s_mov_b32 s63, 1.0
    s_mov_b32 s52, 0x3eb8aa3b
    s_mov_b32 s53, 0x3eb8aa3b
    s_waitcnt lgkmcnt(9)
    v_mfma_f32_32x32x16_bf16 v[64:79], v[144:147], v[128:131], v[64:79]
    ds_read_b64_tr_b16 v[160:161], v63 offset:53248
    ds_read_b64_tr_b16 v[162:163], v63 offset:54016
    ds_read_b64_tr_b16 v[164:165], v63 offset:56320
    ds_read_b64_tr_b16 v[166:167], v63 offset:57088
    s_waitcnt lgkmcnt(10)
    v_mfma_f32_32x32x16_bf16 v[64:79], v[148:151], v[132:135], v[64:79]
    ds_read_b64_tr_b16 v[168:169], v63 offset:59392
    ds_read_b64_tr_b16 v[170:171], v63 offset:60160
    ds_read_b64_tr_b16 v[172:173], v63 offset:62464
    s_waitcnt lgkmcnt(10)
    v_mfma_f32_32x32x16_bf16 v[64:79], v[152:155], v[136:139], v[64:79]
    ds_read_b64_tr_b16 v[174:175], v63 offset:63232
    ds_read_b64_tr_b16 v[176:177], v63 offset:53312
    ds_read_b64_tr_b16 v[178:179], v63 offset:54080
    s_waitcnt lgkmcnt(10)
    v_mfma_f32_32x32x16_bf16 v[64:79], v[156:159], v[140:143], v[64:79]
    ds_read_b64_tr_b16 v[180:181], v63 offset:56384
    ds_read_b64_tr_b16 v[182:183], v63 offset:57152
    ds_read_b64_tr_b16 v[184:185], v63 offset:59456
    s_waitcnt lgkmcnt(11)
    v_mfma_f32_32x32x16_bf16 v[80:95], v[160:163], v[128:131], v[80:95]
    ds_read_b64_tr_b16 v[186:187], v63 offset:60224
    ds_read_b64_tr_b16 v[188:189], v63 offset:62528
    s_waitcnt lgkmcnt(11)
    v_mfma_f32_32x32x16_bf16 v[80:95], v[164:167], v[132:135], v[80:95]
    ds_read_b64_tr_b16 v[190:191], v63 offset:63296
    ds_read_b64_tr_b16 v[192:193], v63 offset:53376
    s_waitcnt lgkmcnt(11)
    v_mfma_f32_32x32x16_bf16 v[80:95], v[168:171], v[136:139], v[80:95]
    ds_read_b64_tr_b16 v[194:195], v63 offset:54144
    ds_read_b64_tr_b16 v[196:197], v63 offset:56448
    v_pk_mul_f32 v[64:65], v[64:65], s[52:53]
    v_pk_mul_f32 v[66:67], v[66:67], s[52:53]
    v_pk_mul_f32 v[68:69], v[68:69], s[52:53]
    v_pk_mul_f32 v[70:71], v[70:71], s[52:53]
    v_cvt_pk_bf16_f32 v4, v64, v65
    v_cvt_pk_bf16_f32 v5, v66, v67
    s_waitcnt lgkmcnt(11)
    v_mfma_f32_32x32x16_bf16 v[80:95], v[172:175], v[140:143], v[80:95]
    ds_read_b64_tr_b16 v[198:199], v63 offset:57216
    ds_read_b64_tr_b16 v[200:201], v63 offset:59520
    v_cvt_pk_bf16_f32 v6, v68, v69
    v_cvt_pk_bf16_f32 v7, v70, v71
    ds_write_b128 v243, v[4:7] offset:0
    v_pk_mul_f32 v[72:73], v[72:73], s[52:53]
    v_pk_mul_f32 v[74:75], v[74:75], s[52:53]
    v_pk_mul_f32 v[76:77], v[76:77], s[52:53]
    s_waitcnt lgkmcnt(12)
    v_mfma_f32_32x32x16_bf16 v[96:111], v[176:179], v[128:131], v[96:111]
    ds_read_b64_tr_b16 v[202:203], v63 offset:60288
    v_pk_mul_f32 v[78:79], v[78:79], s[52:53]
    v_cvt_pk_bf16_f32 v8, v72, v73
    v_cvt_pk_bf16_f32 v9, v74, v75
    v_cvt_pk_bf16_f32 v10, v76, v77
    v_cvt_pk_bf16_f32 v11, v78, v79
    ds_write_b128 v243, v[8:11] offset:1024
    s_waitcnt lgkmcnt(12)
    v_mfma_f32_32x32x16_bf16 v[96:111], v[180:183], v[132:135], v[96:111]
    ds_read_b64_tr_b16 v[204:205], v63 offset:62592
    s_waitcnt lgkmcnt(11)
    v_mfma_f32_32x32x16_bf16 v[96:111], v[184:187], v[136:139], v[96:111]
    ds_read_b64_tr_b16 v[206:207], v63 offset:63360
    v_pk_mul_f32 v[208:209], v[80:81], s[54:55]
    v_pk_mul_f32 v[210:211], v[82:83], s[54:55]
    v_pk_mul_f32 v[212:213], v[84:85], s[54:55]
    v_pk_mul_f32 v[214:215], v[86:87], s[54:55]
    v_pk_mul_f32 v[216:217], v[88:89], s[54:55]
    v_pk_mul_f32 v[218:219], v[90:91], s[54:55]
    s_waitcnt lgkmcnt(10)
    v_mfma_f32_32x32x16_bf16 v[96:111], v[188:191], v[140:143], v[96:111]
    v_pk_mul_f32 v[220:221], v[92:93], s[54:55]
    v_pk_mul_f32 v[222:223], v[94:95], s[54:55]
    v_exp_f32 v208, v208
    v_exp_f32 v209, v209
    s_waitcnt lgkmcnt(8)
    v_mfma_f32_32x32x16_bf16 v[112:127], v[192:195], v[128:131], v[112:127]
    v_exp_f32 v210, v210
    v_exp_f32 v211, v211
    v_exp_f32 v212, v212
    s_waitcnt lgkmcnt(6)
    v_mfma_f32_32x32x16_bf16 v[112:127], v[196:199], v[132:135], v[112:127]
    v_exp_f32 v213, v213
    v_exp_f32 v214, v214
    v_exp_f32 v215, v215
    s_waitcnt lgkmcnt(3)
    v_mfma_f32_32x32x16_bf16 v[112:127], v[200:203], v[136:139], v[112:127]
    v_exp_f32 v216, v216
    v_exp_f32 v217, v217
    v_exp_f32 v218, v218
    s_waitcnt lgkmcnt(0)
    v_mfma_f32_32x32x16_bf16 v[112:127], v[204:207], v[140:143], v[112:127]
    v_exp_f32 v219, v219
    v_exp_f32 v220, v220
    v_exp_f32 v221, v221
    ds_add_u32 v240, v241 offset:24
    s_setprio 3
    v_exp_f32 v222, v222
    v_exp_f32 v223, v223
    v_pk_add_f32 v[208:209], v[208:209], s[62:63]
    v_pk_add_f32 v[210:211], v[210:211], s[62:63]
    v_pk_add_f32 v[212:213], v[212:213], s[62:63]
    v_pk_add_f32 v[214:215], v[214:215], s[62:63]
    v_pk_add_f32 v[216:217], v[216:217], s[62:63]
    v_pk_add_f32 v[218:219], v[218:219], s[62:63]
    v_pk_add_f32 v[220:221], v[220:221], s[62:63]
    v_pk_add_f32 v[222:223], v[222:223], s[62:63]
    v_rcp_f32 v208, v208
    v_rcp_f32 v209, v209
    v_rcp_f32 v210, v210
    v_rcp_f32 v211, v211
    v_rcp_f32 v212, v212
    v_rcp_f32 v213, v213
    v_rcp_f32 v214, v214
    v_rcp_f32 v215, v215
    v_rcp_f32 v216, v216
    v_rcp_f32 v217, v217
    v_rcp_f32 v218, v218
    v_rcp_f32 v219, v219
    v_rcp_f32 v220, v220
    v_rcp_f32 v221, v221
    v_rcp_f32 v222, v222
    v_rcp_f32 v223, v223
    v_pk_mul_f32 v[208:209], v[208:209], v[80:81]
    v_pk_mul_f32 v[210:211], v[210:211], v[82:83]
    v_pk_mul_f32 v[212:213], v[212:213], v[84:85]
    v_pk_mul_f32 v[214:215], v[214:215], v[86:87]
    v_pk_mul_f32 v[216:217], v[216:217], v[88:89]
    v_pk_mul_f32 v[218:219], v[218:219], v[90:91]
    v_pk_mul_f32 v[220:221], v[220:221], v[92:93]
    v_pk_mul_f32 v[222:223], v[222:223], v[94:95]
    v_cvt_pk_bf16_f32 v32, v208, v209
    v_cvt_pk_bf16_f32 v33, v210, v211
    v_cvt_pk_bf16_f32 v34, v212, v213
    v_cvt_pk_bf16_f32 v35, v214, v215
    v_cvt_pk_bf16_f32 v36, v216, v217
    v_cvt_pk_bf16_f32 v37, v218, v219
    v_cvt_pk_bf16_f32 v38, v220, v221
    v_cvt_pk_bf16_f32 v39, v222, v223
L_g:
    s_add_u32 s52, s48, 32
    s_lshl_b32 s52, s52, 10
    s_bfe_u32 s53, s2, 0x40003
    s_mul_i32 s53, s53, 8320
    s_add_u32 s53, s53, s52
    s_sub_u32 s3, s53, 133120
    s_min_u32 s53, s53, s3
    s_cmp_ge_u32 s30, 14
    s_cbranch_scc1 L_send_27
    v_pk_mul_f32 v[16:17], v[96:97], s[54:55]
    v_pk_mul_f32 v[18:19], v[98:99], s[54:55]
    v_pk_mul_f32 v[20:21], v[100:101], s[54:55]
    v_pk_mul_f32 v[22:23], v[102:103], s[54:55]
    v_pk_mul_f32 v[24:25], v[104:105], s[54:55]
    v_pk_mul_f32 v[26:27], v[106:107], s[54:55]
    v_pk_mul_f32 v[28:29], v[108:109], s[54:55]
    v_pk_mul_f32 v[30:31], v[110:111], s[54:55]
    v_exp_f32 v16, v16
    v_exp_f32 v17, v17
    v_exp_f32 v18, v18
    v_exp_f32 v19, v19
    v_exp_f32 v20, v20
    v_exp_f32 v21, v21
    v_exp_f32 v22, v22
    v_exp_f32 v23, v23
    v_exp_f32 v24, v24
    v_exp_f32 v25, v25
    v_exp_f32 v26, v26
    v_exp_f32 v27, v27
    v_exp_f32 v28, v28
    v_exp_f32 v29, v29
    v_exp_f32 v30, v30
    v_exp_f32 v31, v31
    v_pk_add_f32 v[16:17], v[16:17], s[62:63]
    v_pk_add_f32 v[18:19], v[18:19], s[62:63]
    v_pk_add_f32 v[20:21], v[20:21], s[62:63]
    v_pk_add_f32 v[22:23], v[22:23], s[62:63]
    v_pk_add_f32 v[24:25], v[24:25], s[62:63]
    v_pk_add_f32 v[26:27], v[26:27], s[62:63]
    v_pk_add_f32 v[28:29], v[28:29], s[62:63]
    v_pk_add_f32 v[30:31], v[30:31], s[62:63]
    v_rcp_f32 v16, v16
    v_rcp_f32 v17, v17
    v_rcp_f32 v18, v18
    v_rcp_f32 v19, v19
    v_rcp_f32 v20, v20
    v_rcp_f32 v21, v21
    v_rcp_f32 v22, v22
    v_rcp_f32 v23, v23
    v_rcp_f32 v24, v24
    v_rcp_f32 v25, v25
    v_rcp_f32 v26, v26
    v_rcp_f32 v27, v27
    v_rcp_f32 v28, v28
    v_rcp_f32 v29, v29
    v_rcp_f32 v30, v30
    v_rcp_f32 v31, v31
    v_pk_mul_f32 v[16:17], v[16:17], v[96:97]
    v_pk_mul_f32 v[18:19], v[18:19], v[98:99]
    v_pk_mul_f32 v[20:21], v[20:21], v[100:101]
    v_pk_mul_f32 v[22:23], v[22:23], v[102:103]
    v_pk_mul_f32 v[24:25], v[24:25], v[104:105]
    v_pk_mul_f32 v[26:27], v[26:27], v[106:107]
    v_pk_mul_f32 v[28:29], v[28:29], v[108:109]
    v_pk_mul_f32 v[30:31], v[30:31], v[110:111]
    v_cvt_pk_bf16_f32 v40, v16, v17
    v_cvt_pk_bf16_f32 v41, v18, v19
    v_cvt_pk_bf16_f32 v42, v20, v21
    v_cvt_pk_bf16_f32 v43, v22, v23
    v_cvt_pk_bf16_f32 v44, v24, v25
    v_cvt_pk_bf16_f32 v45, v26, v27
    v_cvt_pk_bf16_f32 v46, v28, v29
    v_cvt_pk_bf16_f32 v47, v30, v31
L_send_27:
    s_mov_b32 s97, 8388608
L_sp_28:
    ds_read_b32 v12, v240 offset:24
    s_waitcnt lgkmcnt(0)
    v_readfirstlane_b32 s3, v12
    s_sub_u32 s97, s97, 1
    s_cbranch_scc1 L_spd_29
    s_cmp_ge_u32 s3, 8
    s_cbranch_scc1 L_spd_29
    s_branch L_sp_28
L_spd_29:
    s_mov_b32 s97, 1048576
    s_mov_b32 m0, s52
    s_add_u32 s52, s52, 4096
    buffer_load_dwordx4 v1, s[32:35], s53 offen sc1 lds
    s_add_u32 s53, s53, 4096
    s_sub_u32 s3, s53, 133120
    s_min_u32 s53, s53, s3
    s_mov_b32 m0, s52
    s_add_u32 s52, s52, 4096
    buffer_load_dwordx4 v1, s[32:35], s53 offen sc1 lds
    s_add_u32 s53, s53, 4096
    s_sub_u32 s3, s53, 133120
    s_min_u32 s53, s53, s3
    s_mov_b32 m0, s52
    s_add_u32 s52, s52, 4096
    buffer_load_dwordx4 v1, s[32:35], s53 offen sc1 lds
    s_add_u32 s53, s53, 4096
    s_sub_u32 s3, s53, 133120
    s_min_u32 s53, s53, s3
    s_mov_b32 m0, s52
    s_add_u32 s52, s52, 4096
    buffer_load_dwordx4 v1, s[32:35], s53 offen sc1 lds
    s_add_u32 s53, s53, 4096
    s_sub_u32 s3, s53, 133120
    s_min_u32 s53, s53, s3
    s_mov_b32 m0, s52
    s_add_u32 s52, s52, 4096
    buffer_load_dwordx4 v1, s[32:35], s53 offen sc1 lds
    s_add_u32 s53, s53, 4096
    s_sub_u32 s3, s53, 133120
    s_min_u32 s53, s53, s3
    s_mov_b32 m0, s52
    s_add_u32 s52, s52, 4096
    buffer_load_dwordx4 v1, s[32:35], s53 offen sc1 lds
    s_add_u32 s53, s53, 4096
    s_sub_u32 s3, s53, 133120
    s_min_u32 s53, s53, s3
    s_mov_b32 m0, s52
    s_add_u32 s52, s52, 4096
    buffer_load_dwordx4 v1, s[32:35], s53 offen sc1 lds
    s_add_u32 s53, s53, 4096
    s_sub_u32 s3, s53, 133120
    s_min_u32 s53, s53, s3
    s_mov_b32 m0, s52
    s_add_u32 s52, s52, 4096
    buffer_load_dwordx4 v1, s[32:35], s53 offen sc1 lds
    s_add_u32 s53, s53, 4096
    s_sub_u32 s3, s53, 133120
    s_min_u32 s53, s53, s3
    s_mov_b32 m0, s52
    s_add_u32 s52, s52, 4096
    buffer_load_dwordx4 v1, s[32:35], s53 offen sc1 lds
    s_add_u32 s53, s53, 4096
    s_sub_u32 s3, s53, 133120
    s_min_u32 s53, s53, s3
    s_mov_b32 m0, s52
    s_add_u32 s52, s52, 4096
    buffer_load_dwordx4 v1, s[32:35], s53 offen sc1 lds
    s_add_u32 s53, s53, 4096
    s_sub_u32 s3, s53, 133120
    s_min_u32 s53, s53, s3
    s_mov_b32 m0, s52
    s_add_u32 s52, s52, 4096
    buffer_load_dwordx4 v1, s[32:35], s53 offen sc1 lds
    s_add_u32 s53, s53, 4096
    s_sub_u32 s3, s53, 133120
    s_min_u32 s53, s53, s3
    s_mov_b32 m0, s52
    s_add_u32 s52, s52, 4096
    buffer_load_dwordx4 v1, s[32:35], s53 offen sc1 lds
    s_add_u32 s53, s53, 4096
    s_sub_u32 s3, s53, 133120
    s_min_u32 s53, s53, s3
    s_mov_b32 m0, s52
    s_add_u32 s52, s52, 4096
    buffer_load_dwordx4 v1, s[32:35], s53 offen sc1 lds
    s_add_u32 s53, s53, 4096
    s_sub_u32 s3, s53, 133120
    s_min_u32 s53, s53, s3
    s_mov_b32 m0, s52
    s_add_u32 s52, s52, 4096
    buffer_load_dwordx4 v1, s[32:35], s53 offen sc1 lds
    s_add_u32 s53, s53, 4096
    s_sub_u32 s3, s53, 133120
    s_min_u32 s53, s53, s3
    s_mov_b32 m0, s52
    s_add_u32 s52, s52, 4096
    buffer_load_dwordx4 v1, s[32:35], s53 offen sc1 lds
    s_add_u32 s53, s53, 4096
    s_sub_u32 s3, s53, 133120
    s_min_u32 s53, s53, s3
    s_mov_b32 m0, s52
    s_add_u32 s52, s52, 4096
    buffer_load_dwordx4 v1, s[32:35], s53 offen sc1 lds
    s_add_u32 s53, s53, 4096
    s_sub_u32 s3, s53, 133120
    s_min_u32 s53, s53, s3
    s_mov_b32 m0, s52
    s_add_u32 s52, s52, 4096
    buffer_load_dwordx4 v1, s[32:35], s53 offen sc1 lds
    s_add_u32 s53, s53, 4096
    s_sub_u32 s3, s53, 133120
    s_min_u32 s53, s53, s3
    s_mov_b32 m0, s52
    s_add_u32 s52, s52, 4096
    buffer_load_dwordx4 v1, s[32:35], s53 offen sc1 lds
    s_add_u32 s53, s53, 4096
    s_sub_u32 s3, s53, 133120
    s_min_u32 s53, s53, s3
    s_mov_b32 m0, s52
    s_add_u32 s52, s52, 4096
    buffer_load_dwordx4 v1, s[32:35], s53 offen sc1 lds
    s_add_u32 s53, s53, 4096
    s_sub_u32 s3, s53, 133120
    s_min_u32 s53, s53, s3
    s_mov_b32 m0, s52
    s_add_u32 s52, s52, 4096
    buffer_load_dwordx4 v1, s[32:35], s53 offen sc1 lds
    s_add_u32 s53, s53, 4096
    s_sub_u32 s3, s53, 133120
    s_min_u32 s53, s53, s3
    s_mov_b32 m0, s52
    s_add_u32 s52, s52, 4096
    buffer_load_dwordx4 v1, s[32:35], s53 offen sc1 lds
    s_add_u32 s53, s53, 4096
    s_sub_u32 s3, s53, 133120
    s_min_u32 s53, s53, s3
    s_mov_b32 m0, s52
    s_add_u32 s52, s52, 4096
    buffer_load_dwordx4 v1, s[32:35], s53 offen sc1 lds
    s_add_u32 s53, s53, 4096
    s_sub_u32 s3, s53, 133120
    s_min_u32 s53, s53, s3
    s_mov_b32 m0, s52
    s_add_u32 s52, s52, 4096
    buffer_load_dwordx4 v1, s[32:35], s53 offen sc1 lds
    s_add_u32 s53, s53, 4096
    s_sub_u32 s3, s53, 133120
    s_min_u32 s53, s53, s3
    s_mov_b32 m0, s52
    s_add_u32 s52, s52, 4096
    buffer_load_dwordx4 v1, s[32:35], s53 offen sc1 lds
    s_add_u32 s53, s53, 4096
    s_sub_u32 s3, s53, 133120
    s_min_u32 s53, s53, s3
    s_cmp_lt_u32 s48, 2
    s_cbranch_scc0 L_kvp_30
    s_mov_b32 m0, s52
    s_add_u32 s52, s52, 4096
    buffer_load_dwordx4 v1, s[32:35], s53 offen sc1 lds
    s_add_u32 s53, s53, 4096
    s_sub_u32 s3, s53, 133120
    s_min_u32 s53, s53, s3
L_kvp_30:
    s_cmp_ge_u32 s30, 14
    s_cbranch_scc1 L_send_31
    v_pk_mul_f32 v[16:17], v[112:113], s[54:55]
    v_pk_mul_f32 v[18:19], v[114:115], s[54:55]
    v_pk_mul_f32 v[20:21], v[116:117], s[54:55]
    v_pk_mul_f32 v[22:23], v[118:119], s[54:55]
    v_pk_mul_f32 v[24:25], v[120:121], s[54:55]
    v_pk_mul_f32 v[26:27], v[122:123], s[54:55]
    v_pk_mul_f32 v[28:29], v[124:125], s[54:55]
    v_pk_mul_f32 v[30:31], v[126:127], s[54:55]
    v_exp_f32 v16, v16
    v_exp_f32 v17, v17
    v_exp_f32 v18, v18
    v_exp_f32 v19, v19
    v_exp_f32 v20, v20
    v_exp_f32 v21, v21
    v_exp_f32 v22, v22
    v_exp_f32 v23, v23
    v_exp_f32 v24, v24
    v_exp_f32 v25, v25
    v_exp_f32 v26, v26
    v_exp_f32 v27, v27
    v_exp_f32 v28, v28
    v_exp_f32 v29, v29
    v_exp_f32 v30, v30
    v_exp_f32 v31, v31
    v_pk_add_f32 v[16:17], v[16:17], s[62:63]
    v_pk_add_f32 v[18:19], v[18:19], s[62:63]
    v_pk_add_f32 v[20:21], v[20:21], s[62:63]
    v_pk_add_f32 v[22:23], v[22:23], s[62:63]
    v_pk_add_f32 v[24:25], v[24:25], s[62:63]
    v_pk_add_f32 v[26:27], v[26:27], s[62:63]
    v_pk_add_f32 v[28:29], v[28:29], s[62:63]
    v_pk_add_f32 v[30:31], v[30:31], s[62:63]
    v_rcp_f32 v16, v16
    v_rcp_f32 v17, v17
    v_rcp_f32 v18, v18
    v_rcp_f32 v19, v19
    v_rcp_f32 v20, v20
    v_rcp_f32 v21, v21
    v_rcp_f32 v22, v22
    v_rcp_f32 v23, v23
    v_rcp_f32 v24, v24
    v_rcp_f32 v25, v25
    v_rcp_f32 v26, v26
    v_rcp_f32 v27, v27
    v_rcp_f32 v28, v28
    v_rcp_f32 v29, v29
    v_rcp_f32 v30, v30
    v_rcp_f32 v31, v31
    v_pk_mul_f32 v[16:17], v[16:17], v[112:113]
    v_pk_mul_f32 v[18:19], v[18:19], v[114:115]
    v_pk_mul_f32 v[20:21], v[20:21], v[116:117]
    v_pk_mul_f32 v[22:23], v[22:23], v[118:119]
    v_pk_mul_f32 v[24:25], v[24:25], v[120:121]
    v_pk_mul_f32 v[26:27], v[26:27], v[122:123]
    v_pk_mul_f32 v[28:29], v[28:29], v[124:125]
    v_pk_mul_f32 v[30:31], v[30:31], v[126:127]
    v_cvt_pk_bf16_f32 v48, v16, v17
    v_cvt_pk_bf16_f32 v49, v18, v19
    v_cvt_pk_bf16_f32 v50, v20, v21
    v_cvt_pk_bf16_f32 v51, v22, v23
    v_cvt_pk_bf16_f32 v52, v24, v25
    v_cvt_pk_bf16_f32 v53, v26, v27
    v_cvt_pk_bf16_f32 v54, v28, v29
    v_cvt_pk_bf16_f32 v55, v30, v31
L_send_31:
    s_waitcnt vmcnt(0)
    ds_add_u32 v240, v241 offset:0
L_sp_32:
    ds_read_b32 v12, v240 offset:0
    s_waitcnt lgkmcnt(0)
    v_readfirstlane_b32 s3, v12
    s_sub_u32 s97, s97, 1
    s_cbranch_scc1 L_spd_33
    s_cmp_ge_u32 s3, 4
    s_cbranch_scc1 L_spd_33
    s_branch L_sp_32
L_spd_33:
    s_mov_b32 s97, 1048576
    s_lshr_b32 s3, s2, 3
    s_lshl_b32 s3, s3, 2
    s_add_u32 s56, s3, s48
    v_lshlrev_b32 v12, 7, v0
    s_mov_b32 s40, s12
    s_mov_b32 s41, s13
    s_mov_b32 s42, 524288
    s_mov_b32 s43, 0x20000
    s_lshl_b32 s3, s56, 12
    s_mov_b32 exec_hi, 0
    buffer_load_dword v13, v12, s[40:43], s3 offen
    s_mov_b64 exec, -1
    buffer_store_dwordx4 v[244:247], v1, s[32:35], s50 offen sc1
    buffer_store_dwordx4 v[244:247], v1, s[32:35], s50 offen offset:1024 sc1
    s_mul_i32 s51, s58, 86
    s_mul_i32 s3, s30, 6
    s_add_u32 s51, s51, s3
    s_lshl_b32 s51, s51, 10
    s_add_u32 s51, s51, 5242880
    s_cmp_eq_u32 s30, 15
    s_cbranch_scc1 L_hkv_35
    buffer_store_dwordx4 v[32:35], v1, s[32:35], s51 offen offset:0 sc1
    buffer_store_dwordx4 v[36:39], v1, s[32:35], s51 offen offset:1024 sc1
    s_cmp_eq_u32 s30, 14
    s_cbranch_scc1 L_hend_34
    buffer_store_dwordx4 v[40:43], v1, s[32:35], s51 offen offset:2048 sc1
    buffer_store_dwordx4 v[44:47], v1, s[32:35], s51 offen offset:3072 sc1
    s_add_u32 s51, s51, 4096
    buffer_store_dwordx4 v[48:51], v1, s[32:35], s51 offen offset:0 sc1
    buffer_store_dwordx4 v[52:55], v1, s[32:35], s51 offen offset:1024 sc1
    s_branch L_hend_34
L_hkv_35:
    s_lshl_b32 s3, s58, 7
    s_add_u32 s3, s3, 262144
    buffer_store_dword v112, v239, s[32:35], s3 offen sc1
L_hend_34:
    v_mov_b32 v2, v232
    v_mov_b32 v3, v233
    v_mov_b32 v4, v234
    v_mov_b32 v5, v235
    v_mov_b32 v6, v236
    v_mov_b32 v7, v237
    v_mov_b32 v8, v238
    v_mov_b32 v9, v239
    v_mov_b32 v10, v240
    v_mov_b32 v11, v241
    v_mov_b32 v63, v242
    s_lshl_b32 s50, s29, 8
    s_add_u32 s50, s50, 327680
L_sp_36:
    ds_read_b32 v12, v10 offset:20
    s_waitcnt lgkmcnt(0)
    v_readfirstlane_b32 s3, v12
    s_sub_u32 s97, s97, 1
    s_cbranch_scc1 L_spd_37
    s_cmp_ge_u32 s3, 4
    s_cbranch_scc1 L_spd_37
    s_sleep 1
    s_branch L_sp_36
L_spd_37:
    s_mov_b32 s97, 1048576
    s_mov_b32 s40, s12
    s_mov_b32 s41, s13
    s_mov_b32 s42, 524288
    s_mov_b32 s43, 0x20000
    s_lshr_b32 s63, s48, 1
    s_lshl_b32 s63, s63, 18
    s_add_u32 m0, s60, 0
    s_nop 0
    buffer_load_dwordx4 v4, s[40:43], s63 offen lds
    s_add_u32 m0, s60, 1024
    s_nop 0
    buffer_load_dwordx4 v5, s[40:43], s63 offen lds
    s_add_u32 s63, s63, 32768
    s_add_u32 m0, s60, 2048
    s_nop 0
    buffer_load_dwordx4 v4, s[40:43], s63 offen lds
    s_add_u32 m0, s60, 3072
    s_nop 0
    buffer_load_dwordx4 v5, s[40:43], s63 offen lds
    s_add_u32 s63, s63, 32768
    s_add_u32 m0, s60, 4096
    s_nop 0
    buffer_load_dwordx4 v4, s[40:43], s63 offen lds
    s_add_u32 m0, s60, 5120
    s_nop 0
    buffer_load_dwordx4 v5, s[40:43], s63 offen lds
    s_add_u32 s63, s63, 32768
    s_waitcnt vmcnt(0)
    ds_add_rtn_u32 v12, v10, v11 offset:16
    s_waitcnt lgkmcnt(0)
    v_readfirstlane_b32 s3, v12
    s_cmp_eq_u32 s3, 3
    s_cbranch_scc0 L_noarr_38
    s_mov_b64 exec, 1
    buffer_atomic_add v11, v8, s[32:35], s50 offen sc1
    s_mov_b64 exec, -1
    s_waitcnt vmcnt(1)
L_noarr_38:
    s_waitcnt vmcnt(4)
    ds_read_b64_tr_b16 v[128:129], v6 offset:0
    ds_read_b64_tr_b16 v[130:131], v6 offset:1024
    ds_read_b64_tr_b16 v[132:133], v7 offset:0
    ds_read_b64_tr_b16 v[134:135], v7 offset:1024
    s_waitcnt lgkmcnt(0)
    s_add_u32 m0, s60, 0
    s_nop 0
    buffer_load_dwordx4 v4, s[40:43], s63 offen lds
    s_add_u32 m0, s60, 1024
    s_nop 0
    buffer_load_dwordx4 v5, s[40:43], s63 offen lds
    s_add_u32 s63, s63, 32768
    s_waitcnt vmcnt(4)
    ds_read_b64_tr_b16 v[136:137], v6 offset:2048
    ds_read_b64_tr_b16 v[138:139], v6 offset:3072
    ds_read_b64_tr_b16 v[140:141], v7 offset:2048
    ds_read_b64_tr_b16 v[142:143], v7 offset:3072
    s_waitcnt lgkmcnt(0)
    s_add_u32 m0, s60, 2048
    s_nop 0
    buffer_load_dwordx4 v4, s[40:43], s63 offen lds
    s_add_u32 m0, s60, 3072
    s_nop 0
    buffer_load_dwordx4 v5, s[40:43], s63 offen lds
    s_add_u32 s63, s63, 32768
    s_waitcnt vmcnt(4)
    ds_read_b64_tr_b16 v[144:145], v6 offset:4096
    ds_read_b64_tr_b16 v[146:147], v6 offset:5120
    ds_read_b64_tr_b16 v[148:149], v7 offset:4096
    ds_read_b64_tr_b16 v[150:151], v7 offset:5120
    s_waitcnt lgkmcnt(0)
    s_add_u32 m0, s60, 4096
    s_nop 0
    buffer_load_dwordx4 v4, s[40:43], s63 offen lds
    s_add_u32 m0, s60, 5120
    s_nop 0
    buffer_load_dwordx4 v5, s[40:43], s63 offen lds
    s_add_u32 s63, s63, 32768
    s_waitcnt vmcnt(4)
    ds_read_b64_tr_b16 v[152:153], v6 offset:0
    ds_read_b64_tr_b16 v[154:155], v6 offset:1024
    ds_read_b64_tr_b16 v[156:157], v7 offset:0
    ds_read_b64_tr_b16 v[158:159], v7 offset:1024
    s_waitcnt lgkmcnt(0)
    s_add_u32 m0, s60, 0
    s_nop 0
    buffer_load_dwordx4 v4, s[40:43], s63 offen lds
    s_add_u32 m0, s60, 1024
    s_nop 0
    buffer_load_dwordx4 v5, s[40:43], s63 offen lds
    s_add_u32 s63, s63, 32768
    s_waitcnt vmcnt(4)
    ds_read_b64_tr_b16 v[160:161], v6 offset:2048
    ds_read_b64_tr_b16 v[162:163], v6 offset:3072
    ds_read_b64_tr_b16 v[164:165], v7 offset:2048
    ds_read_b64_tr_b16 v[166:167], v7 offset:3072
    s_waitcnt lgkmcnt(0)
    s_add_u32 m0, s60, 2048
    s_nop 0
    buffer_load_dwordx4 v4, s[40:43], s63 offen lds
    s_add_u32 m0, s60, 3072
    s_nop 0
    buffer_load_dwordx4 v5, s[40:43], s63 offen lds
    s_sub_u32 s63, s63, 212992
    s_waitcnt vmcnt(4)
    ds_read_b64_tr_b16 v[168:169], v6 offset:4096
    ds_read_b64_tr_b16 v[170:171], v6 offset:5120
    ds_read_b64_tr_b16 v[172:173], v7 offset:4096
    ds_read_b64_tr_b16 v[174:175], v7 offset:5120
    s_waitcnt lgkmcnt(0)
    s_add_u32 m0, s60, 4096
    s_nop 0
    buffer_load_dwordx4 v4, s[40:43], s63 offen lds
    s_add_u32 m0, s60, 5120
    s_nop 0
    buffer_load_dwordx4 v5, s[40:43], s63 offen lds
    s_add_u32 s63, s63, 32768
    s_waitcnt vmcnt(4)
    ds_read_b64_tr_b16 v[176:177], v6 offset:0
    ds_read_b64_tr_b16 v[178:179], v6 offset:1024
    ds_read_b64_tr_b16 v[180:181], v7 offset:0
    ds_read_b64_tr_b16 v[182:183], v7 offset:1024
    s_waitcnt lgkmcnt(0)
    s_add_u32 m0, s60, 0
    s_nop 0
    buffer_load_dwordx4 v4, s[40:43], s63 offen lds
    s_add_u32 m0, s60, 1024
    s_nop 0
    buffer_load_dwordx4 v5, s[40:43], s63 offen lds
    s_add_u32 s63, s63, 32768
    s_waitcnt vmcnt(4)
    ds_read_b64_tr_b16 v[184:185], v6 offset:2048
    ds_read_b64_tr_b16 v[186:187], v6 offset:3072
    ds_read_b64_tr_b16 v[188:189], v7 offset:2048
    ds_read_b64_tr_b16 v[190:191], v7 offset:3072
    s_waitcnt lgkmcnt(0)
    s_add_u32 m0, s60, 2048
    s_nop 0
    buffer_load_dwordx4 v4, s[40:43], s63 offen lds
    s_add_u32 m0, s60, 3072
    s_nop 0
    buffer_load_dwordx4 v5, s[40:43], s63 offen lds
    s_add_u32 s63, s63, 32768
    s_waitcnt vmcnt(4)
    ds_read_b64_tr_b16 v[192:193], v6 offset:4096
    ds_read_b64_tr_b16 v[194:195], v6 offset:5120
    ds_read_b64_tr_b16 v[196:197], v7 offset:4096
    ds_read_b64_tr_b16 v[198:199], v7 offset:5120
    s_waitcnt lgkmcnt(0)
    s_add_u32 m0, s60, 4096
    s_nop 0
    buffer_load_dwordx4 v4, s[40:43], s63 offen lds
    s_add_u32 m0, s60, 5120
    s_nop 0
    buffer_load_dwordx4 v5, s[40:43], s63 offen lds
    s_add_u32 s63, s63, 32768
    s_waitcnt vmcnt(4)
    ds_read_b64_tr_b16 v[200:201], v6 offset:0
    ds_read_b64_tr_b16 v[202:203], v6 offset:1024
    ds_read_b64_tr_b16 v[204:205], v7 offset:0
    ds_read_b64_tr_b16 v[206:207], v7 offset:1024
    s_waitcnt lgkmcnt(0)
    s_add_u32 m0, s60, 0
    s_nop 0
    buffer_load_dwordx4 v4, s[40:43], s63 offen lds
    s_add_u32 m0, s60, 1024
    s_nop 0
    buffer_load_dwordx4 v5, s[40:43], s63 offen lds
    s_add_u32 s63, s63, 32768
    s_waitcnt vmcnt(4)
    ds_read_b64_tr_b16 v[208:209], v6 offset:2048
    ds_read_b64_tr_b16 v[210:211], v6 offset:3072
    ds_read_b64_tr_b16 v[212:213], v7 offset:2048
    ds_read_b64_tr_b16 v[214:215], v7 offset:3072
    s_waitcnt lgkmcnt(0)
    s_add_u32 m0, s60, 2048
    s_nop 0
    buffer_load_dwordx4 v4, s[40:43], s63 offen lds
    s_add_u32 m0, s60, 3072
    s_nop 0
    buffer_load_dwordx4 v5, s[40:43], s63 offen lds
    s_add_u32 s63, s63, 32768
    s_waitcnt vmcnt(4)
    ds_read_b64_tr_b16 v[216:217], v6 offset:4096
    ds_read_b64_tr_b16 v[218:219], v6 offset:5120
    ds_read_b64_tr_b16 v[220:221], v7 offset:4096
    ds_read_b64_tr_b16 v[222:223], v7 offset:5120
    s_waitcnt lgkmcnt(0)
    s_add_u32 m0, s60, 4096
    s_nop 0
    buffer_load_dwordx4 v4, s[40:43], s63 offen lds
    s_add_u32 m0, s60, 5120
    s_nop 0
    buffer_load_dwordx4 v5, s[40:43], s63 offen lds
    s_add_u32 s63, s63, 32768
    s_waitcnt vmcnt(4)
    ds_read_b64_tr_b16 v[224:225], v6 offset:0
    ds_read_b64_tr_b16 v[226:227], v6 offset:1024
    ds_read_b64_tr_b16 v[228:229], v7 offset:0
    ds_read_b64_tr_b16 v[230:231], v7 offset:1024
    s_waitcnt lgkmcnt(0)
    s_add_u32 m0, s60, 0
    s_nop 0
    buffer_load_dwordx4 v4, s[40:43], s63 offen lds
    s_add_u32 m0, s60, 1024
    s_nop 0
    buffer_load_dwordx4 v5, s[40:43], s63 offen lds
    s_add_u32 s63, s63, 32768
    s_waitcnt vmcnt(4)
    ds_read_b64_tr_b16 v[232:233], v6 offset:2048
    ds_read_b64_tr_b16 v[234:235], v6 offset:3072
    ds_read_b64_tr_b16 v[236:237], v7 offset:2048
    ds_read_b64_tr_b16 v[238:239], v7 offset:3072
    s_waitcnt vmcnt(2)
    ds_read_b64_tr_b16 v[240:241], v6 offset:4096
    ds_read_b64_tr_b16 v[242:243], v6 offset:5120
    ds_read_b64_tr_b16 v[244:245], v7 offset:4096
    ds_read_b64_tr_b16 v[246:247], v7 offset:5120
    s_waitcnt vmcnt(0)
    ds_read_b64_tr_b16 v[248:249], v6 offset:0
    ds_read_b64_tr_b16 v[250:251], v6 offset:1024
    ds_read_b64_tr_b16 v[252:253], v7 offset:0
    ds_read_b64_tr_b16 v[254:255], v7 offset:1024
    s_waitcnt lgkmcnt(0)
    s_mov_b64 exec, 1
L_hw_39:
    buffer_load_dword v12, v8, s[32:35], s50 offen sc1
    s_waitcnt vmcnt(0)
    v_cmp_le_u32 vcc, 16, v12
    s_sub_u32 s97, s97, 1
    s_cbranch_scc1 L_hd_40
    s_cbranch_vccnz L_hd_40
    s_sleep 8
    s_branch L_hw_39
L_hd_40:
    s_mov_b64 exec, -1
    s_mov_b32 s97, 1048576
    s_lshl_b32 s3, s59, 7
    s_add_u32 s3, s3, 262144
    buffer_load_dword v60, v9, s[32:35], s3 offen sc1
    s_lshl_b32 s3, s58, 7
    s_add_u32 s3, s3, 262144
    buffer_load_dword v62, v9, s[32:35], s3 offen sc1
    s_mov_b32 s40, s18
    s_mov_b32 s41, s19
    s_mov_b32 s42, 1409024
    s_mov_b32 s43, 0x20000
    s_cmp_lt_u32 s48, 2
    s_mov_b32 s49, 17
    s_mov_b32 s53, s49
    s_mov_b32 s56, s49
    s_lshr_b32 s52, s2, 5
    s_and_b32 s3, s29, 3
    s_lshl_b32 s3, s3, 1
    s_add_u32 s52, s52, s3
    s_and_b32 s52, s52, 7
    s_lshl_b32 s52, s52, 1
    s_lshl_b32 s51, s48, 14
    s_lshl_b32 s62, s52, 12
    s_lshl_b32 s63, s52, 16
    s_add_u32 s63, s63, s51
    s_add_u32 s52, s52, 1
    s_cmp_eq_u32 s52, s53
    s_cselect_b32 s52, 0, s52
    s_sub_u32 s56, s56, 1
    s_cmp_lt_i32 s56, 0
    s_cselect_b32 s62, 0x10000000, s62
    s_cselect_b32 s63, 0x10000000, s63
    s_add_u32 m0, s60, 0
    buffer_load_dwordx4 v[28:31], v2, s[32:35], s62 offen sc1
    buffer_load_dwordx4 v4, s[40:43], s63 offen lds
    s_add_u32 m0, s60, 1024
    buffer_load_dwordx4 v[32:35], v3, s[32:35], s62 offen sc1
    buffer_load_dwordx4 v5, s[40:43], s63 offen lds
    s_lshl_b32 s62, s52, 12
    s_lshl_b32 s63, s52, 16
    s_add_u32 s63, s63, s51
    s_add_u32 s52, s52, 1
    s_cmp_eq_u32 s52, s53
    s_cselect_b32 s52, 0, s52
    s_sub_u32 s56, s56, 1
    s_cmp_lt_i32 s56, 0
    s_cselect_b32 s62, 0x10000000, s62
    s_cselect_b32 s63, 0x10000000, s63
    s_add_u32 m0, s60, 2048
    buffer_load_dwordx4 v[36:39], v2, s[32:35], s62 offen sc1
    buffer_load_dwordx4 v4, s[40:43], s63 offen lds
    s_add_u32 m0, s60, 3072
    buffer_load_dwordx4 v[40:43], v3, s[32:35], s62 offen sc1
    buffer_load_dwordx4 v5, s[40:43], s63 offen lds
    s_lshl_b32 s62, s52, 12
    s_lshl_b32 s63, s52, 16
    s_add_u32 s63, s63, s51
    s_add_u32 s52, s52, 1
    s_cmp_eq_u32 s52, s53
    s_cselect_b32 s52, 0, s52
    s_sub_u32 s56, s56, 1
    s_cmp_lt_i32 s56, 0
    s_cselect_b32 s62, 0x10000000, s62
    s_cselect_b32 s63, 0x10000000, s63
    s_add_u32 m0, s60, 4096
    buffer_load_dwordx4 v[44:47], v2, s[32:35], s62 offen sc1
    buffer_load_dwordx4 v4, s[40:43], s63 offen lds
    s_add_u32 m0, s60, 5120
    buffer_load_dwordx4 v[48:51], v3, s[32:35], s62 offen sc1
    buffer_load_dwordx4 v5, s[40:43], s63 offen lds
    s_waitcnt vmcnt(8)
    ds_write_b32 v63, v62
    ds_read_b64_tr_b16 v[12:13], v6 offset:0
    ds_read_b64_tr_b16 v[14:15], v6 offset:1024
    ds_read_b64_tr_b16 v[16:17], v7 offset:0
    ds_read_b64_tr_b16 v[18:19], v7 offset:1024
    s_waitcnt lgkmcnt(0)
    ds_add_u32 v10, v11 offset:4
    s_lshl_b32 s62, s52, 12
    s_lshl_b32 s63, s52, 16
    s_add_u32 s63, s63, s51
    s_add_u32 s52, s52, 1
    s_cmp_eq_u32 s52, s53
    s_cselect_b32 s52, 0, s52
    s_sub_u32 s56, s56, 1
    s_cmp_lt_i32 s56, 0
    s_cselect_b32 s62, 0x10000000, s62
    s_cselect_b32 s63, 0x10000000, s63
    s_add_u32 m0, s60, 0
    buffer_load_dwordx4 v[52:55], v2, s[32:35], s62 offen sc1
    buffer_load_dwordx4 v4, s[40:43], s63 offen lds
    s_add_u32 m0, s60, 1024
    buffer_load_dwordx4 v[56:59], v3, s[32:35], s62 offen sc1
    buffer_load_dwordx4 v5, s[40:43], s63 offen lds
    s_setprio 0
    s_waitcnt vmcnt(8)
    v_mfma_f32_32x32x16_bf16 v[64:79], v[12:15], v[28:31], 0
    ds_read_b64_tr_b16 v[20:21], v6 offset:2048
    ds_read_b64_tr_b16 v[22:23], v6 offset:3072
    v_mfma_f32_32x32x16_bf16 v[80:95], v[12:15], v[32:35], 0
    ds_read_b64_tr_b16 v[24:25], v7 offset:2048
    ds_read_b64_tr_b16 v[26:27], v7 offset:3072
    v_mfma_f32_32x32x16_bf16 v[96:111], v[16:19], v[28:31], 0
    s_sub_u32 s49, s49, 1
    s_cmp_eq_u32 s49, 0
    v_mfma_f32_32x32x16_bf16 v[112:127], v[16:19], v[32:35], 0
    s_branch L_gl1_43
L_gloop_41:
    s_waitcnt vmcnt(8)
    v_mfma_f32_32x32x16_bf16 v[64:79], v[12:15], v[28:31], v[64:79]
    ds_read_b64_tr_b16 v[20:21], v6 offset:2048
    ds_read_b64_tr_b16 v[22:23], v6 offset:3072
    v_mfma_f32_32x32x16_bf16 v[80:95], v[12:15], v[32:35], v[80:95]
    ds_read_b64_tr_b16 v[24:25], v7 offset:2048
    ds_read_b64_tr_b16 v[26:27], v7 offset:3072
    v_mfma_f32_32x32x16_bf16 v[96:111], v[16:19], v[28:31], v[96:111]
    s_sub_u32 s49, s49, 1
    s_cmp_eq_u32 s49, 0
    v_mfma_f32_32x32x16_bf16 v[112:127], v[16:19], v[32:35], v[112:127]
    s_cbranch_scc1 L_gend_42
L_gl1_43:
    s_waitcnt lgkmcnt(0)
    s_lshl_b32 s62, s52, 12
    s_lshl_b32 s63, s52, 16
    s_add_u32 s63, s63, s51
    s_add_u32 s52, s52, 1
    s_cmp_eq_u32 s52, s53
    s_cselect_b32 s52, 0, s52
    s_sub_u32 s56, s56, 1
    s_cmp_lt_i32 s56, 0
    s_cselect_b32 s62, 0x10000000, s62
    s_cselect_b32 s63, 0x10000000, s63
    s_add_u32 m0, s60, 2048
    buffer_load_dwordx4 v[28:31], v2, s[32:35], s62 offen sc1
    buffer_load_dwordx4 v4, s[40:43], s63 offen lds
    s_add_u32 m0, s60, 3072
    buffer_load_dwordx4 v[32:35], v3, s[32:35], s62 offen sc1
    buffer_load_dwordx4 v5, s[40:43], s63 offen lds
    s_waitcnt vmcnt(8)
    v_mfma_f32_32x32x16_bf16 v[64:79], v[20:23], v[36:39], v[64:79]
    ds_read_b64_tr_b16 v[12:13], v6 offset:4096
    ds_read_b64_tr_b16 v[14:15], v6 offset:5120
    v_mfma_f32_32x32x16_bf16 v[80:95], v[20:23], v[40:43], v[80:95]
    ds_read_b64_tr_b16 v[16:17], v7 offset:4096
    ds_read_b64_tr_b16 v[18:19], v7 offset:5120
    v_mfma_f32_32x32x16_bf16 v[96:111], v[24:27], v[36:39], v[96:111]
    s_sub_u32 s49, s49, 1
    s_cmp_eq_u32 s49, 0
    v_mfma_f32_32x32x16_bf16 v[112:127], v[24:27], v[40:43], v[112:127]
    s_cbranch_scc1 L_gend_42
    s_waitcnt lgkmcnt(0)
    s_lshl_b32 s62, s52, 12
    s_lshl_b32 s63, s52, 16
    s_add_u32 s63, s63, s51
    s_add_u32 s52, s52, 1
    s_cmp_eq_u32 s52, s53
    s_cselect_b32 s52, 0, s52
    s_sub_u32 s56, s56, 1
    s_cmp_lt_i32 s56, 0
    s_cselect_b32 s62, 0x10000000, s62
    s_cselect_b32 s63, 0x10000000, s63
    s_add_u32 m0, s60, 4096
    buffer_load_dwordx4 v[36:39], v2, s[32:35], s62 offen sc1
    buffer_load_dwordx4 v4, s[40:43], s63 offen lds
    s_add_u32 m0, s60, 5120
    buffer_load_dwordx4 v[40:43], v3, s[32:35], s62 offen sc1
    buffer_load_dwordx4 v5, s[40:43], s63 offen lds
    s_waitcnt vmcnt(8)
    v_mfma_f32_32x32x16_bf16 v[64:79], v[12:15], v[44:47], v[64:79]
    ds_read_b64_tr_b16 v[20:21], v6 offset:0
    ds_read_b64_tr_b16 v[22:23], v6 offset:1024
    v_mfma_f32_32x32x16_bf16 v[80:95], v[12:15], v[48:51], v[80:95]
    ds_read_b64_tr_b16 v[24:25], v7 offset:0
    ds_read_b64_tr_b16 v[26:27], v7 offset:1024
    v_mfma_f32_32x32x16_bf16 v[96:111], v[16:19], v[44:47], v[96:111]
    s_sub_u32 s49, s49, 1
    s_cmp_eq_u32 s49, 0
    v_mfma_f32_32x32x16_bf16 v[112:127], v[16:19], v[48:51], v[112:127]
    s_cbranch_scc1 L_gend_42
    s_waitcnt lgkmcnt(0)
    s_lshl_b32 s62, s52, 12
    s_lshl_b32 s63, s52, 16
    s_add_u32 s63, s63, s51
    s_add_u32 s52, s52, 1
    s_cmp_eq_u32 s52, s53
    s_cselect_b32 s52, 0, s52
    s_sub_u32 s56, s56, 1
    s_cmp_lt_i32 s56, 0
    s_cselect_b32 s62, 0x10000000, s62
    s_cselect_b32 s63, 0x10000000, s63
    s_add_u32 m0, s60, 0
    buffer_load_dwordx4 v[44:47], v2, s[32:35], s62 offen sc1
    buffer_load_dwordx4 v4, s[40:43], s63 offen lds
    s_add_u32 m0, s60, 1024
    buffer_load_dwordx4 v[48:51], v3, s[32:35], s62 offen sc1
    buffer_load_dwordx4 v5, s[40:43], s63 offen lds
    s_waitcnt vmcnt(8)
    v_mfma_f32_32x32x16_bf16 v[64:79], v[20:23], v[52:55], v[64:79]
    ds_read_b64_tr_b16 v[12:13], v6 offset:2048
    ds_read_b64_tr_b16 v[14:15], v6 offset:3072
    v_mfma_f32_32x32x16_bf16 v[80:95], v[20:23], v[56:59], v[80:95]
    ds_read_b64_tr_b16 v[16:17], v7 offset:2048
    ds_read_b64_tr_b16 v[18:19], v7 offset:3072
    v_mfma_f32_32x32x16_bf16 v[96:111], v[24:27], v[52:55], v[96:111]
    s_sub_u32 s49, s49, 1
    s_cmp_eq_u32 s49, 0
    v_mfma_f32_32x32x16_bf16 v[112:127], v[24:27], v[56:59], v[112:127]
    s_cbranch_scc1 L_gend_42
    s_waitcnt lgkmcnt(0)
    s_lshl_b32 s62, s52, 12
    s_lshl_b32 s63, s52, 16
    s_add_u32 s63, s63, s51
    s_add_u32 s52, s52, 1
    s_cmp_eq_u32 s52, s53
    s_cselect_b32 s52, 0, s52
    s_sub_u32 s56, s56, 1
    s_cmp_lt_i32 s56, 0
    s_cselect_b32 s62, 0x10000000, s62
    s_cselect_b32 s63, 0x10000000, s63
    s_add_u32 m0, s60, 2048
    buffer_load_dwordx4 v[52:55], v2, s[32:35], s62 offen sc1
    buffer_load_dwordx4 v4, s[40:43], s63 offen lds
    s_add_u32 m0, s60, 3072
    buffer_load_dwordx4 v[56:59], v3, s[32:35], s62 offen sc1
    buffer_load_dwordx4 v5, s[40:43], s63 offen lds
    s_waitcnt vmcnt(8)
    v_mfma_f32_32x32x16_bf16 v[64:79], v[12:15], v[28:31], v[64:79]
    ds_read_b64_tr_b16 v[20:21], v6 offset:4096
    ds_read_b64_tr_b16 v[22:23], v6 offset:5120
    v_mfma_f32_32x32x16_bf16 v[80:95], v[12:15], v[32:35], v[80:95]
    ds_read_b64_tr_b16 v[24:25], v7 offset:4096
    ds_read_b64_tr_b16 v[26:27], v7 offset:5120
    v_mfma_f32_32x32x16_bf16 v[96:111], v[16:19], v[28:31], v[96:111]
    s_sub_u32 s49, s49, 1
    s_cmp_eq_u32 s49, 0
    v_mfma_f32_32x32x16_bf16 v[112:127], v[16:19], v[32:35], v[112:127]
    s_cbranch_scc1 L_gend_42
    s_waitcnt lgkmcnt(0)
    s_lshl_b32 s62, s52, 12
    s_lshl_b32 s63, s52, 16
    s_add_u32 s63, s63, s51
    s_add_u32 s52, s52, 1
    s_cmp_eq_u32 s52, s53
    s_cselect_b32 s52, 0, s52
    s_sub_u32 s56, s56, 1
    s_cmp_lt_i32 s56, 0
    s_cselect_b32 s62, 0x10000000, s62
    s_cselect_b32 s63, 0x10000000, s63
    s_add_u32 m0, s60, 4096
    buffer_load_dwordx4 v[28:31], v2, s[32:35], s62 offen sc1
    buffer_load_dwordx4 v4, s[40:43], s63 offen lds
    s_add_u32 m0, s60, 5120
    buffer_load_dwordx4 v[32:35], v3, s[32:35], s62 offen sc1
    buffer_load_dwordx4 v5, s[40:43], s63 offen lds
    s_waitcnt vmcnt(8)
    v_mfma_f32_32x32x16_bf16 v[64:79], v[20:23], v[36:39], v[64:79]
    ds_read_b64_tr_b16 v[12:13], v6 offset:0
    ds_read_b64_tr_b16 v[14:15], v6 offset:1024
    v_mfma_f32_32x32x16_bf16 v[80:95], v[20:23], v[40:43], v[80:95]
    ds_read_b64_tr_b16 v[16:17], v7 offset:0
    ds_read_b64_tr_b16 v[18:19], v7 offset:1024
    v_mfma_f32_32x32x16_bf16 v[96:111], v[24:27], v[36:39], v[96:111]
    s_sub_u32 s49, s49, 1
    s_cmp_eq_u32 s49, 0
    v_mfma_f32_32x32x16_bf16 v[112:127], v[24:27], v[40:43], v[112:127]
    s_cbranch_scc1 L_gend_42
    s_waitcnt lgkmcnt(0)
    s_lshl_b32 s62, s52, 12
    s_lshl_b32 s63, s52, 16
    s_add_u32 s63, s63, s51
    s_add_u32 s52, s52, 1
    s_cmp_eq_u32 s52, s53
    s_cselect_b32 s52, 0, s52
    s_sub_u32 s56, s56, 1
    s_cmp_lt_i32 s56, 0
    s_cselect_b32 s62, 0x10000000, s62
    s_cselect_b32 s63, 0x10000000, s63
    s_add_u32 m0, s60, 0
    buffer_load_dwordx4 v[36:39], v2, s[32:35], s62 offen sc1
    buffer_load_dwordx4 v4, s[40:43], s63 offen lds
    s_add_u32 m0, s60, 1024
    buffer_load_dwordx4 v[40:43], v3, s[32:35], s62 offen sc1
    buffer_load_dwordx4 v5, s[40:43], s63 offen lds
    s_waitcnt vmcnt(8)
    v_mfma_f32_32x32x16_bf16 v[64:79], v[12:15], v[44:47], v[64:79]
    ds_read_b64_tr_b16 v[20:21], v6 offset:2048
    ds_read_b64_tr_b16 v[22:23], v6 offset:3072
    v_mfma_f32_32x32x16_bf16 v[80:95], v[12:15], v[48:51], v[80:95]
    ds_read_b64_tr_b16 v[24:25], v7 offset:2048
    ds_read_b64_tr_b16 v[26:27], v7 offset:3072
    v_mfma_f32_32x32x16_bf16 v[96:111], v[16:19], v[44:47], v[96:111]
    s_sub_u32 s49, s49, 1
    s_cmp_eq_u32 s49, 0
    v_mfma_f32_32x32x16_bf16 v[112:127], v[16:19], v[48:51], v[112:127]
    s_cbranch_scc1 L_gend_42
    s_waitcnt lgkmcnt(0)
    s_lshl_b32 s62, s52, 12
    s_lshl_b32 s63, s52, 16
    s_add_u32 s63, s63, s51
    s_add_u32 s52, s52, 1
    s_cmp_eq_u32 s52, s53
    s_cselect_b32 s52, 0, s52
    s_sub_u32 s56, s56, 1
    s_cmp_lt_i32 s56, 0
    s_cselect_b32 s62, 0x10000000, s62
    s_cselect_b32 s63, 0x10000000, s63
    s_add_u32 m0, s60, 2048
    buffer_load_dwordx4 v[44:47], v2, s[32:35], s62 offen sc1
    buffer_load_dwordx4 v4, s[40:43], s63 offen lds
    s_add_u32 m0, s60, 3072
    buffer_load_dwordx4 v[48:51], v3, s[32:35], s62 offen sc1
    buffer_load_dwordx4 v5, s[40:43], s63 offen lds
    s_waitcnt vmcnt(8)
    v_mfma_f32_32x32x16_bf16 v[64:79], v[20:23], v[52:55], v[64:79]
    ds_read_b64_tr_b16 v[12:13], v6 offset:4096
    ds_read_b64_tr_b16 v[14:15], v6 offset:5120
    v_mfma_f32_32x32x16_bf16 v[80:95], v[20:23], v[56:59], v[80:95]
    ds_read_b64_tr_b16 v[16:17], v7 offset:4096
    ds_read_b64_tr_b16 v[18:19], v7 offset:5120
    v_mfma_f32_32x32x16_bf16 v[96:111], v[24:27], v[52:55], v[96:111]
    s_sub_u32 s49, s49, 1
    s_cmp_eq_u32 s49, 0
    v_mfma_f32_32x32x16_bf16 v[112:127], v[24:27], v[56:59], v[112:127]
    s_cbranch_scc1 L_gend_42
    s_waitcnt lgkmcnt(0)
    s_lshl_b32 s62, s52, 12
    s_lshl_b32 s63, s52, 16
    s_add_u32 s63, s63, s51
    s_add_u32 s52, s52, 1
    s_cmp_eq_u32 s52, s53
    s_cselect_b32 s52, 0, s52
    s_sub_u32 s56, s56, 1
    s_cmp_lt_i32 s56, 0
    s_cselect_b32 s62, 0x10000000, s62
    s_cselect_b32 s63, 0x10000000, s63
    s_add_u32 m0, s60, 4096
    buffer_load_dwordx4 v[52:55], v2, s[32:35], s62 offen sc1
    buffer_load_dwordx4 v4, s[40:43], s63 offen lds
    s_add_u32 m0, s60, 5120
    buffer_load_dwordx4 v[56:59], v3, s[32:35], s62 offen sc1
    buffer_load_dwordx4 v5, s[40:43], s63 offen lds
    s_waitcnt vmcnt(8)
    v_mfma_f32_32x32x16_bf16 v[64:79], v[12:15], v[28:31], v[64:79]
    ds_read_b64_tr_b16 v[20:21], v6 offset:0
    ds_read_b64_tr_b16 v[22:23], v6 offset:1024
    v_mfma_f32_32x32x16_bf16 v[80:95], v[12:15], v[32:35], v[80:95]
    ds_read_b64_tr_b16 v[24:25], v7 offset:0
    ds_read_b64_tr_b16 v[26:27], v7 offset:1024
    v_mfma_f32_32x32x16_bf16 v[96:111], v[16:19], v[28:31], v[96:111]
    s_sub_u32 s49, s49, 1
    s_cmp_eq_u32 s49, 0
    v_mfma_f32_32x32x16_bf16 v[112:127], v[16:19], v[32:35], v[112:127]
    s_cbranch_scc1 L_gend_42
    s_waitcnt lgkmcnt(0)
    s_lshl_b32 s62, s52, 12
    s_lshl_b32 s63, s52, 16
    s_add_u32 s63, s63, s51
    s_add_u32 s52, s52, 1
    s_cmp_eq_u32 s52, s53
    s_cselect_b32 s52, 0, s52
    s_sub_u32 s56, s56, 1
    s_cmp_lt_i32 s56, 0
    s_cselect_b32 s62, 0x10000000, s62
    s_cselect_b32 s63, 0x10000000, s63
    s_add_u32 m0, s60, 0
    buffer_load_dwordx4 v[28:31], v2, s[32:35], s62 offen sc1
    buffer_load_dwordx4 v4, s[40:43], s63 offen lds
    s_add_u32 m0, s60, 1024
    buffer_load_dwordx4 v[32:35], v3, s[32:35], s62 offen sc1
    buffer_load_dwordx4 v5, s[40:43], s63 offen lds
    s_waitcnt vmcnt(8)
    v_mfma_f32_32x32x16_bf16 v[64:79], v[20:23], v[36:39], v[64:79]
    ds_read_b64_tr_b16 v[12:13], v6 offset:2048
    ds_read_b64_tr_b16 v[14:15], v6 offset:3072
    v_mfma_f32_32x32x16_bf16 v[80:95], v[20:23], v[40:43], v[80:95]
    ds_read_b64_tr_b16 v[16:17], v7 offset:2048
    ds_read_b64_tr_b16 v[18:19], v7 offset:3072
    v_mfma_f32_32x32x16_bf16 v[96:111], v[24:27], v[36:39], v[96:111]
    s_sub_u32 s49, s49, 1
    s_cmp_eq_u32 s49, 0
    v_mfma_f32_32x32x16_bf16 v[112:127], v[24:27], v[40:43], v[112:127]
    s_cbranch_scc1 L_gend_42
    s_waitcnt lgkmcnt(0)
    s_lshl_b32 s62, s52, 12
    s_lshl_b32 s63, s52, 16
    s_add_u32 s63, s63, s51
    s_add_u32 s52, s52, 1
    s_cmp_eq_u32 s52, s53
    s_cselect_b32 s52, 0, s52
    s_sub_u32 s56, s56, 1
    s_cmp_lt_i32 s56, 0
    s_cselect_b32 s62, 0x10000000, s62
    s_cselect_b32 s63, 0x10000000, s63
    s_add_u32 m0, s60, 2048
    buffer_load_dwordx4 v[36:39], v2, s[32:35], s62 offen sc1
    buffer_load_dwordx4 v4, s[40:43], s63 offen lds
    s_add_u32 m0, s60, 3072
    buffer_load_dwordx4 v[40:43], v3, s[32:35], s62 offen sc1
    buffer_load_dwordx4 v5, s[40:43], s63 offen lds
    s_waitcnt vmcnt(8)
    v_mfma_f32_32x32x16_bf16 v[64:79], v[12:15], v[44:47], v[64:79]
    ds_read_b64_tr_b16 v[20:21], v6 offset:4096
    ds_read_b64_tr_b16 v[22:23], v6 offset:5120
    v_mfma_f32_32x32x16_bf16 v[80:95], v[12:15], v[48:51], v[80:95]
    ds_read_b64_tr_b16 v[24:25], v7 offset:4096
    ds_read_b64_tr_b16 v[26:27], v7 offset:5120
    v_mfma_f32_32x32x16_bf16 v[96:111], v[16:19], v[44:47], v[96:111]
    s_sub_u32 s49, s49, 1
    s_cmp_eq_u32 s49, 0
    v_mfma_f32_32x32x16_bf16 v[112:127], v[16:19], v[48:51], v[112:127]
    s_cbranch_scc1 L_gend_42
    s_waitcnt lgkmcnt(0)
    s_lshl_b32 s62, s52, 12
    s_lshl_b32 s63, s52, 16
    s_add_u32 s63, s63, s51
    s_add_u32 s52, s52, 1
    s_cmp_eq_u32 s52, s53
    s_cselect_b32 s52, 0, s52
    s_sub_u32 s56, s56, 1
    s_cmp_lt_i32 s56, 0
    s_cselect_b32 s62, 0x10000000, s62
    s_cselect_b32 s63, 0x10000000, s63
    s_add_u32 m0, s60, 4096
    buffer_load_dwordx4 v[44:47], v2, s[32:35], s62 offen sc1
    buffer_load_dwordx4 v4, s[40:43], s63 offen lds
    s_add_u32 m0, s60, 5120
    buffer_load_dwordx4 v[48:51], v3, s[32:35], s62 offen sc1
    buffer_load_dwordx4 v5, s[40:43], s63 offen lds
    s_waitcnt vmcnt(8)
    v_mfma_f32_32x32x16_bf16 v[64:79], v[20:23], v[52:55], v[64:79]
    ds_read_b64_tr_b16 v[12:13], v6 offset:0
    ds_read_b64_tr_b16 v[14:15], v6 offset:1024
    v_mfma_f32_32x32x16_bf16 v[80:95], v[20:23], v[56:59], v[80:95]
    ds_read_b64_tr_b16 v[16:17], v7 offset:0
    ds_read_b64_tr_b16 v[18:19], v7 offset:1024
    v_mfma_f32_32x32x16_bf16 v[96:111], v[24:27], v[52:55], v[96:111]
    s_sub_u32 s49, s49, 1
    s_cmp_eq_u32 s49, 0
    v_mfma_f32_32x32x16_bf16 v[112:127], v[24:27], v[56:59], v[112:127]
    s_cbranch_scc1 L_gend_42
    s_waitcnt lgkmcnt(0)
    s_lshl_b32 s62, s52, 12
    s_lshl_b32 s63, s52, 16
    s_add_u32 s63, s63, s51
    s_add_u32 s52, s52, 1
    s_cmp_eq_u32 s52, s53
    s_cselect_b32 s52, 0, s52
    s_sub_u32 s56, s56, 1
    s_cmp_lt_i32 s56, 0
    s_cselect_b32 s62, 0x10000000, s62
    s_cselect_b32 s63, 0x10000000, s63
    s_add_u32 m0, s60, 0
    buffer_load_dwordx4 v[52:55], v2, s[32:35], s62 offen sc1
    buffer_load_dwordx4 v4, s[40:43], s63 offen lds
    s_add_u32 m0, s60, 1024
    buffer_load_dwordx4 v[56:59], v3, s[32:35], s62 offen sc1
    buffer_load_dwordx4 v5, s[40:43], s63 offen lds
    s_branch L_gloop_41
L_gend_42:
    s_setprio 3
    s_waitcnt vmcnt(0) lgkmcnt(0)
    v_add_u32 v8, s60, v1
    s_xor_b32 s3, s48, 1
    s_mul_i32 s3, s3, 7424
    s_add_u32 s3, s3, 133120
    v_add_u32 v9, s3, v1
    v_mul_f32 v60, 0x3fb8aa3b, v60
    v_exp_f32 v60, v60
    s_nop 0
    v_add_f32 v60, 1.0, v60
    v_rcp_f32 v60, v60
    s_nop 0
    v_mov_b32 v61, v60
    ds_write_b128 v8, v[80:83] offset:0
    ds_write_b128 v8, v[84:87] offset:1024
    ds_write_b128 v8, v[88:91] offset:2048
    ds_write_b128 v8, v[92:95] offset:3072
    s_waitcnt lgkmcnt(0)
    s_add_u32 s57, s57, 4
    ds_add_u32 v10, v11 offset:8
L_sp_44:
    ds_read_b32 v12, v10 offset:8
    s_waitcnt lgkmcnt(0)
    v_readfirstlane_b32 s3, v12
    s_sub_u32 s97, s97, 1
    s_cbranch_scc1 L_spd_45
    s_cmp_ge_u32 s3, s57
    s_cbranch_scc1 L_spd_45
    s_branch L_sp_44
L_spd_45:
    s_mov_b32 s97, 1048576
    ds_read_b128 v[80:83], v9 offset:0
    ds_read_b128 v[84:87], v9 offset:1024
    ds_read_b128 v[88:91], v9 offset:2048
    ds_read_b128 v[92:95], v9 offset:3072
    s_waitcnt lgkmcnt(0)
    s_add_u32 s57, s57, 4
    ds_add_u32 v10, v11 offset:8
L_sp_46:
    ds_read_b32 v12, v10 offset:8
    s_waitcnt lgkmcnt(0)
    v_readfirstlane_b32 s3, v12
    s_sub_u32 s97, s97, 1
    s_cbranch_scc1 L_spd_47
    s_cmp_ge_u32 s3, s57
    s_cbranch_scc1 L_spd_47
    s_branch L_sp_46
L_spd_47:
    s_mov_b32 s97, 1048576
    v_pk_add_f32 v[64:65], v[64:65], v[80:81]
    v_pk_add_f32 v[66:67], v[66:67], v[82:83]
    v_pk_add_f32 v[68:69], v[68:69], v[84:85]
    v_pk_add_f32 v[70:71], v[70:71], v[86:87]
    v_pk_add_f32 v[72:73], v[72:73], v[88:89]
    v_pk_add_f32 v[74:75], v[74:75], v[90:91]
    v_pk_add_f32 v[76:77], v[76:77], v[92:93]
    v_pk_add_f32 v[78:79], v[78:79], v[94:95]
    ds_write_b128 v8, v[112:115] offset:0
    ds_write_b128 v8, v[116:119] offset:1024
    ds_write_b128 v8, v[120:123] offset:2048
    ds_write_b128 v8, v[124:127] offset:3072
    s_waitcnt lgkmcnt(0)
    s_add_u32 s57, s57, 4
    ds_add_u32 v10, v11 offset:8
L_sp_48:
    ds_read_b32 v12, v10 offset:8
    s_waitcnt lgkmcnt(0)
    v_readfirstlane_b32 s3, v12
    s_sub_u32 s97, s97, 1
    s_cbranch_scc1 L_spd_49
    s_cmp_ge_u32 s3, s57
    s_cbranch_scc1 L_spd_49
    s_branch L_sp_48
L_spd_49:
    s_mov_b32 s97, 1048576
    ds_read_b128 v[112:115], v9 offset:0
    ds_read_b128 v[116:119], v9 offset:1024
    ds_read_b128 v[120:123], v9 offset:2048
    ds_read_b128 v[124:127], v9 offset:3072
    s_waitcnt lgkmcnt(0)
    v_pk_add_f32 v[96:97], v[96:97], v[112:113]
    v_pk_add_f32 v[98:99], v[98:99], v[114:115]
    v_pk_add_f32 v[100:101], v[100:101], v[116:117]
    v_pk_add_f32 v[102:103], v[102:103], v[118:119]
    v_pk_add_f32 v[104:105], v[104:105], v[120:121]
    v_pk_add_f32 v[106:107], v[106:107], v[122:123]
    v_pk_add_f32 v[108:109], v[108:109], v[124:125]
    v_pk_add_f32 v[110:111], v[110:111], v[126:127]
    s_add_u32 s57, s57, 4
    ds_add_u32 v10, v11 offset:8
L_sp_50:
    ds_read_b32 v12, v10 offset:8
    s_waitcnt lgkmcnt(0)
    v_readfirstlane_b32 s3, v12
    s_sub_u32 s97, s97, 1
    s_cbranch_scc1 L_spd_51
    s_cmp_ge_u32 s3, s57
    s_cbranch_scc1 L_spd_51
    s_branch L_sp_50
L_spd_51:
    s_mov_b32 s97, 1048576
    s_lshr_b32 s3, s48, 1
    s_mul_i32 s52, s3, 9
    s_add_u32 s52, s52, 68
    s_and_b32 s3, s48, 1
    s_mul_i32 s3, s3, 3
    s_add_u32 s63, s52, s3
    s_lshl_b32 s63, s63, 14
    s_add_u32 m0, s60, 0
    s_nop 0
    buffer_load_dwordx4 v4, s[40:43], s63 offen lds
    s_add_u32 m0, s60, 1024
    s_nop 0
    buffer_load_dwordx4 v5, s[40:43], s63 offen lds
    s_add_u32 s63, s63, 16384
    s_add_u32 m0, s60, 2048
    s_nop 0
    buffer_load_dwordx4 v4, s[40:43], s63 offen lds
    s_add_u32 m0, s60, 3072
    s_nop 0
    buffer_load_dwordx4 v5, s[40:43], s63 offen lds
    s_add_u32 s63, s63, 16384
    s_add_u32 m0, s60, 4096
    s_nop 0
    buffer_load_dwordx4 v4, s[40:43], s63 offen lds
    s_add_u32 m0, s60, 5120
    s_nop 0
    buffer_load_dwordx4 v5, s[40:43], s63 offen lds
    s_add_u32 s63, s63, 16384
    s_sub_u32 s62, s52, s48
    s_lshl_b32 s62, s62, 10
    buffer_load_dwordx4 v[116:119], v2, s[32:35], s62 offen offset:0 sc1
    buffer_load_dwordx4 v[120:123], v2, s[32:35], s62 offen offset:1024 sc1
    buffer_load_dwordx4 v[124:127], v2, s[32:35], s62 offen offset:2048 sc1
    buffer_load_dwordx4 v[28:31], v2, s[32:35], s62 offen offset:3072 sc1
    s_add_u32 s62, s62, 4096
    buffer_load_dwordx4 v[32:35], v2, s[32:35], s62 offen offset:0 sc1
    buffer_load_dwordx4 v[36:39], v2, s[32:35], s62 offen offset:1024 sc1
    buffer_load_dwordx4 v[40:43], v2, s[32:35], s62 offen offset:2048 sc1
    buffer_load_dwordx4 v[44:47], v2, s[32:35], s62 offen offset:3072 sc1
    s_add_u32 s62, s62, 4096
    buffer_load_dwordx4 v[48:51], v2, s[32:35], s62 offen offset:0 sc1
    s_and_b32 s3, s48, 1
    s_mul_i32 s3, s3, 7424
    v_subrev_u32 v6, s3, v6
    v_subrev_u32 v7, s3, v7
    s_lshl_b32 s3, s59, 5
    s_lshr_b32 s50, s48, 1
    s_lshl_b32 s51, s50, 4
    s_add_u32 s3, s3, s51
    s_lshl_b32 s3, s3, 10
    s_add_u32 s3, s3, 3145728
    v_add_u32 v2, s3, v1
    s_lshl_b32 s3, s48, 12
    v_add_u32 v8, s3, v1
    s_xor_b32 s3, s3, 0x2000
    v_add_u32 v9, s3, v1
    s_mov_b32 s36, s22
    s_mov_b32 s37, s23
    s_mov_b32 s38, 2097152
    s_mov_b32 s39, 0x20000
    s_lshl_b32 s50, s50, 6
    s_lshl_b32 s3, s59, 15
    s_add_u32 s50, s50, s3
    s_lshr_b32 s3, s2, 5
    s_lshl_b32 s3, s3, 7
    s_add_u32 s50, s50, s3
    v_and_b32 v3, 31, v0
    v_lshlrev_b32 v3, 10, v3
    v_lshrrev_b32 v12, 5, v0
    v_lshl_add_u32 v3, v12, 4, v3
    s_waitcnt vmcnt(0)
    s_add_u32 s57, s57, 4
    ds_add_u32 v10, v11 offset:8
L_sp_52:
    ds_read_b32 v12, v10 offset:8
    s_waitcnt lgkmcnt(0)
    v_readfirstlane_b32 s3, v12
    s_sub_u32 s97, s97, 1
    s_cbranch_scc1 L_spd_53
    s_cmp_ge_u32 s3, s57
    s_cbranch_scc1 L_spd_53
    s_branch L_sp_52
L_spd_53:
    s_mov_b32 s97, 1048576
    ds_read_b64_tr_b16 v[12:13], v6 offset:0
    ds_read_b64_tr_b16 v[14:15], v6 offset:1024
    ds_read_b64_tr_b16 v[16:17], v7 offset:0
    ds_read_b64_tr_b16 v[18:19], v7 offset:1024
    ds_read_b64_tr_b16 v[20:21], v6 offset:2048
    ds_read_b64_tr_b16 v[22:23], v6 offset:3072
    ds_read_b64_tr_b16 v[24:25], v7 offset:2048
    ds_read_b64_tr_b16 v[26:27], v7 offset:3072
    ds_read_b64_tr_b16 v[52:53], v6 offset:4096
    ds_read_b64_tr_b16 v[54:55], v6 offset:5120
    ds_read_b64_tr_b16 v[56:57], v7 offset:4096
    ds_read_b64_tr_b16 v[58:59], v7 offset:5120
    s_waitcnt lgkmcnt(0)
    s_add_u32 s57, s57, 4
    ds_add_u32 v10, v11 offset:8
L_sp_54:
    ds_read_b32 v62, v10 offset:8
    s_waitcnt lgkmcnt(0)
    v_readfirstlane_b32 s3, v62
    s_sub_u32 s97, s97, 1
    s_cbranch_scc1 L_spd_55
    s_cmp_ge_u32 s3, s57
    s_cbranch_scc1 L_spd_55
    s_branch L_sp_54
L_spd_55:
    s_mov_b32 s97, 1048576
    s_bitcmp1_b32 s48, 0
    s_cbranch_scc1 L_nost2_56
    s_add_u32 s63, s63, 49152
    s_add_u32 m0, s60, 0
    s_nop 0
    buffer_load_dwordx4 v4, s[40:43], s63 offen lds
    s_add_u32 m0, s60, 1024
    s_nop 0
    buffer_load_dwordx4 v5, s[40:43], s63 offen lds
    s_add_u32 s63, s63, 16384
    s_add_u32 m0, s60, 2048
    s_nop 0
    buffer_load_dwordx4 v4, s[40:43], s63 offen lds
    s_add_u32 m0, s60, 3072
    s_nop 0
    buffer_load_dwordx4 v5, s[40:43], s63 offen lds
    s_add_u32 s63, s63, 16384
    s_add_u32 m0, s60, 4096
    s_nop 0
    buffer_load_dwordx4 v4, s[40:43], s63 offen lds
    s_add_u32 m0, s60, 5120
    s_nop 0
    buffer_load_dwordx4 v5, s[40:43], s63 offen lds
    s_add_u32 s63, s63, 16384
    s_waitcnt vmcnt(0)
L_nost2_56:
    s_barrier
    v_mfma_f32_32x32x16_bf16 v[64:79], v[12:15], v[116:119], v[64:79]
    v_mfma_f32_32x32x16_bf16 v[96:111], v[16:19], v[116:119], v[96:111]
    ds_read_b64_tr_b16 v[12:13], v6 offset:7424
    ds_read_b64_tr_b16 v[14:15], v6 offset:8448
    ds_read_b64_tr_b16 v[16:17], v7 offset:7424
    ds_read_b64_tr_b16 v[18:19], v7 offset:8448
    s_mov_b32 s62, 0
    buffer_load_dwordx4 v[80:83], v2, s[32:35], s62 offen sc1
    s_mov_b32 s62, 2048
    buffer_load_dwordx4 v[84:87], v2, s[32:35], s62 offen sc1
    s_mov_b32 s62, 4096
    buffer_load_dwordx4 v[88:91], v2, s[32:35], s62 offen sc1
    s_mov_b32 s62, 6144
    buffer_load_dwordx4 v[92:95], v2, s[32:35], s62 offen sc1
    s_mov_b32 s62, 8192
    buffer_load_dwordx4 v[112:115], v2, s[32:35], s62 offen sc1
    v_mfma_f32_32x32x16_bf16 v[64:79], v[20:23], v[120:123], v[64:79]
    v_mfma_f32_32x32x16_bf16 v[96:111], v[24:27], v[120:123], v[96:111]
    ds_read_b64_tr_b16 v[20:21], v6 offset:9472
    ds_read_b64_tr_b16 v[22:23], v6 offset:10496
    ds_read_b64_tr_b16 v[24:25], v7 offset:9472
    ds_read_b64_tr_b16 v[26:27], v7 offset:10496
    v_mfma_f32_32x32x16_bf16 v[64:79], v[52:55], v[124:127], v[64:79]
    v_mfma_f32_32x32x16_bf16 v[96:111], v[56:59], v[124:127], v[96:111]
    ds_read_b64_tr_b16 v[52:53], v6 offset:11520
    ds_read_b64_tr_b16 v[54:55], v6 offset:12544
    ds_read_b64_tr_b16 v[56:57], v7 offset:11520
    ds_read_b64_tr_b16 v[58:59], v7 offset:12544
    s_mov_b32 s62, 10240
    buffer_load_dwordx4 v[116:119], v2, s[32:35], s62 offen sc1
    s_mov_b32 s62, 12288
    buffer_load_dwordx4 v[120:123], v2, s[32:35], s62 offen sc1
    s_mov_b32 s62, 14336
    buffer_load_dwordx4 v[124:127], v2, s[32:35], s62 offen sc1
    s_waitcnt lgkmcnt(8)
    v_mfma_f32_32x32x16_bf16 v[64:79], v[12:15], v[28:31], v[64:79]
    v_mfma_f32_32x32x16_bf16 v[96:111], v[16:19], v[28:31], v[96:111]
    ds_read_b64_tr_b16 v[12:13], v6 offset:0
    ds_read_b64_tr_b16 v[14:15], v6 offset:1024
    ds_read_b64_tr_b16 v[16:17], v7 offset:0
    ds_read_b64_tr_b16 v[18:19], v7 offset:1024
    s_waitcnt lgkmcnt(8)
    v_mfma_f32_32x32x16_bf16 v[64:79], v[20:23], v[32:35], v[64:79]
    v_mfma_f32_32x32x16_bf16 v[96:111], v[24:27], v[32:35], v[96:111]
    ds_read_b64_tr_b16 v[20:21], v6 offset:2048
    ds_read_b64_tr_b16 v[22:23], v6 offset:3072
    ds_read_b64_tr_b16 v[24:25], v7 offset:2048
    ds_read_b64_tr_b16 v[26:27], v7 offset:3072
    s_waitcnt lgkmcnt(8)
    v_mfma_f32_32x32x16_bf16 v[64:79], v[52:55], v[36:39], v[64:79]
    v_mfma_f32_32x32x16_bf16 v[96:111], v[56:59], v[36:39], v[96:111]
    ds_read_b64_tr_b16 v[52:53], v6 offset:4096
    ds_read_b64_tr_b16 v[54:55], v6 offset:5120
    ds_read_b64_tr_b16 v[56:57], v7 offset:4096
    ds_read_b64_tr_b16 v[58:59], v7 offset:5120
    s_waitcnt lgkmcnt(8)
    v_mfma_f32_32x32x16_bf16 v[64:79], v[12:15], v[40:43], v[64:79]
    v_mfma_f32_32x32x16_bf16 v[96:111], v[16:19], v[40:43], v[96:111]
    s_waitcnt lgkmcnt(4)
    v_mfma_f32_32x32x16_bf16 v[64:79], v[20:23], v[44:47], v[64:79]
    v_mfma_f32_32x32x16_bf16 v[96:111], v[24:27], v[44:47], v[96:111]
    s_waitcnt lgkmcnt(0)
    v_mfma_f32_32x32x16_bf16 v[64:79], v[52:55], v[48:51], v[64:79]
    v_mfma_f32_32x32x16_bf16 v[96:111], v[56:59], v[48:51], v[96:111]
    s_mov_b32 s62, 1024
    buffer_load_dwordx4 v[28:31], v2, s[32:35], s62 offen offset:0 sc1
    buffer_load_dwordx4 v[32:35], v2, s[32:35], s62 offen offset:2048 sc1
    s_mov_b32 s62, 5120
    buffer_load_dwordx4 v[36:39], v2, s[32:35], s62 offen offset:0 sc1
    buffer_load_dwordx4 v[40:43], v2, s[32:35], s62 offen offset:2048 sc1
    s_mov_b32 s62, 9216
    buffer_load_dwordx4 v[44:47], v2, s[32:35], s62 offen offset:0 sc1
    buffer_load_dwordx4 v[48:51], v2, s[32:35], s62 offen offset:2048 sc1
    s_mov_b32 s62, 13312
    buffer_load_dwordx4 v[52:55], v2, s[32:35], s62 offen offset:0 sc1
    buffer_load_dwordx4 v[56:59], v2, s[32:35], s62 offen offset:2048 sc1
    v_pk_mul_f32 v[64:65], v[64:65], v[60:61]
    v_pk_mul_f32 v[66:67], v[66:67], v[60:61]
    v_pk_mul_f32 v[68:69], v[68:69], v[60:61]
    v_pk_mul_f32 v[70:71], v[70:71], v[60:61]
    v_pk_mul_f32 v[72:73], v[72:73], v[60:61]
    v_pk_mul_f32 v[74:75], v[74:75], v[60:61]
    v_pk_mul_f32 v[76:77], v[76:77], v[60:61]
    v_pk_mul_f32 v[78:79], v[78:79], v[60:61]
    v_pk_mul_f32 v[96:97], v[96:97], v[60:61]
    v_pk_mul_f32 v[98:99], v[98:99], v[60:61]
    v_pk_mul_f32 v[100:101], v[100:101], v[60:61]
    v_pk_mul_f32 v[102:103], v[102:103], v[60:61]
    v_pk_mul_f32 v[104:105], v[104:105], v[60:61]
    v_pk_mul_f32 v[106:107], v[106:107], v[60:61]
    v_pk_mul_f32 v[108:109], v[108:109], v[60:61]
    v_pk_mul_f32 v[110:111], v[110:111], v[60:61]
L_ochk_57:
    s_waitcnt vmcnt(14)
    v_max3_u32 v12, v80, v81, v82
    v_max3_u32 v13, v84, v85, v86
    v_max3_u32 v12, v12, v83, v87
    v_max_u32 v12, v12, v13
    v_cmp_eq_u32 vcc, -1, v12
    s_cbranch_vccnz L_ort_59
L_ook_58:
    v_mfma_f32_32x32x16_bf16 v[96:111], v[132:135], v[80:83], v[96:111]
    v_mfma_f32_32x32x16_bf16 v[64:79], v[128:131], v[80:83], v[64:79]
    v_mfma_f32_32x32x16_bf16 v[96:111], v[140:143], v[84:87], v[96:111]
    v_mfma_f32_32x32x16_bf16 v[64:79], v[136:139], v[84:87], v[64:79]
L_ochk_60:
    s_waitcnt vmcnt(12)
    v_max3_u32 v12, v88, v89, v90
    v_max3_u32 v13, v92, v93, v94
    v_max3_u32 v12, v12, v91, v95
    v_max_u32 v12, v12, v13
    v_cmp_eq_u32 vcc, -1, v12
    s_cbranch_vccnz L_ort_62
L_ook_61:
    v_mfma_f32_32x32x16_bf16 v[96:111], v[148:151], v[88:91], v[96:111]
    v_mfma_f32_32x32x16_bf16 v[64:79], v[144:147], v[88:91], v[64:79]
    v_mfma_f32_32x32x16_bf16 v[96:111], v[156:159], v[92:95], v[96:111]
    v_mfma_f32_32x32x16_bf16 v[64:79], v[152:155], v[92:95], v[64:79]
L_ochk_63:
    s_waitcnt vmcnt(10)
    v_max3_u32 v12, v112, v113, v114
    v_max3_u32 v13, v116, v117, v118
    v_max3_u32 v12, v12, v115, v119
    v_max_u32 v12, v12, v13
    v_cmp_eq_u32 vcc, -1, v12
    s_cbranch_vccnz L_ort_65
L_ook_64:
    v_mfma_f32_32x32x16_bf16 v[96:111], v[164:167], v[112:115], v[96:111]
    v_mfma_f32_32x32x16_bf16 v[64:79], v[160:163], v[112:115], v[64:79]
    v_mfma_f32_32x32x16_bf16 v[96:111], v[172:175], v[116:119], v[96:111]
    v_mfma_f32_32x32x16_bf16 v[64:79], v[168:171], v[116:119], v[64:79]
L_ochk_66:
    s_waitcnt vmcnt(8)
    v_max3_u32 v12, v120, v121, v122
    v_max3_u32 v13, v124, v125, v126
    v_max3_u32 v12, v12, v123, v127
    v_max_u32 v12, v12, v13
    v_cmp_eq_u32 vcc, -1, v12
    s_cbranch_vccnz L_ort_68
L_ook_67:
    v_mfma_f32_32x32x16_bf16 v[96:111], v[180:183], v[120:123], v[96:111]
    v_mfma_f32_32x32x16_bf16 v[64:79], v[176:179], v[120:123], v[64:79]
    v_mfma_f32_32x32x16_bf16 v[96:111], v[188:191], v[124:127], v[96:111]
    v_mfma_f32_32x32x16_bf16 v[64:79], v[184:187], v[124:127], v[64:79]
L_ochk_69:
    s_waitcnt vmcnt(6)
    v_max3_u32 v12, v28, v29, v30
    v_max3_u32 v13, v32, v33, v34
    v_max3_u32 v12, v12, v31, v35
    v_max_u32 v12, v12, v13
    v_cmp_eq_u32 vcc, -1, v12
    s_cbranch_vccnz L_ort_71
L_ook_70:
    v_mfma_f32_32x32x16_bf16 v[96:111], v[196:199], v[28:31], v[96:111]
    v_mfma_f32_32x32x16_bf16 v[64:79], v[192:195], v[28:31], v[64:79]
    v_mfma_f32_32x32x16_bf16 v[96:111], v[204:207], v[32:35], v[96:111]
    v_mfma_f32_32x32x16_bf16 v[64:79], v[200:203], v[32:35], v[64:79]
L_ochk_72:
    s_waitcnt vmcnt(4)
    v_max3_u32 v12, v36, v37, v38
    v_max3_u32 v13, v40, v41, v42
    v_max3_u32 v12, v12, v39, v43
    v_max_u32 v12, v12, v13
    v_cmp_eq_u32 vcc, -1, v12
    s_cbranch_vccnz L_ort_74
L_ook_73:
    v_mfma_f32_32x32x16_bf16 v[96:111], v[212:215], v[36:39], v[96:111]
    v_mfma_f32_32x32x16_bf16 v[96:111], v[220:223], v[40:43], v[96:111]
L_ochk_75:
    s_waitcnt vmcnt(2)
    v_max3_u32 v12, v44, v45, v46
    v_max3_u32 v13, v48, v49, v50
    v_max3_u32 v12, v12, v47, v51
    v_max_u32 v12, v12, v13
    v_cmp_eq_u32 vcc, -1, v12
    s_cbranch_vccnz L_ort_77
L_ook_76:
    v_mfma_f32_32x32x16_bf16 v[96:111], v[228:231], v[44:47], v[96:111]
    v_mfma_f32_32x32x16_bf16 v[96:111], v[236:239], v[48:51], v[96:111]
L_ochk_78:
    s_waitcnt vmcnt(0)
    v_max3_u32 v12, v52, v53, v54
    v_max3_u32 v13, v56, v57, v58
    v_max3_u32 v12, v12, v55, v59
    v_max_u32 v12, v12, v13
    v_cmp_eq_u32 vcc, -1, v12
    s_cbranch_vccnz L_ort_80
L_ook_79:
    v_mfma_f32_32x32x16_bf16 v[96:111], v[244:247], v[52:55], v[96:111]
    v_mfma_f32_32x32x16_bf16 v[96:111], v[252:255], v[56:59], v[96:111]
    v_mfma_f32_32x32x16_bf16 v[64:79], v[208:211], v[36:39], v[64:79]
    v_mfma_f32_32x32x16_bf16 v[64:79], v[216:219], v[40:43], v[64:79]
    s_nop 9
    ds_write_b128 v8, v[96:99] offset:0
    ds_write_b128 v8, v[100:103] offset:1024
    v_mfma_f32_32x32x16_bf16 v[64:79], v[224:227], v[44:47], v[64:79]
    ds_write_b128 v8, v[104:107] offset:2048
    ds_write_b128 v8, v[108:111] offset:3072
    v_mfma_f32_32x32x16_bf16 v[64:79], v[232:235], v[48:51], v[64:79]
    v_mfma_f32_32x32x16_bf16 v[64:79], v[240:243], v[52:55], v[64:79]
    s_waitcnt lgkmcnt(0)
    s_barrier
    ds_read_b128 v[96:99], v9 offset:0
    ds_read_b128 v[100:103], v9 offset:1024
    ds_read_b128 v[104:107], v9 offset:2048
    ds_read_b128 v[108:111], v9 offset:3072
    v_mfma_f32_32x32x16_bf16 v[64:79], v[248:251], v[56:59], v[64:79]
    s_nop 11
    s_waitcnt lgkmcnt(3)
    v_pk_add_f32 v[64:65], v[64:65], v[96:97]
    v_pk_add_f32 v[66:67], v[66:67], v[98:99]
    v_cvt_pk_bf16_f32 v16, v64, v65
    v_cvt_pk_bf16_f32 v17, v66, v67
    s_waitcnt lgkmcnt(2)
    v_pk_add_f32 v[68:69], v[68:69], v[100:101]
    v_pk_add_f32 v[70:71], v[70:71], v[102:103]
    v_cvt_pk_bf16_f32 v18, v68, v69
    v_cvt_pk_bf16_f32 v19, v70, v71
    s_waitcnt lgkmcnt(1)
    v_pk_add_f32 v[72:73], v[72:73], v[104:105]
    v_pk_add_f32 v[74:75], v[74:75], v[106:107]
    v_cvt_pk_bf16_f32 v20, v72, v73
    v_cvt_pk_bf16_f32 v21, v74, v75
    s_waitcnt lgkmcnt(0)
    v_pk_add_f32 v[76:77], v[76:77], v[108:109]
    v_pk_add_f32 v[78:79], v[78:79], v[110:111]
    v_cvt_pk_bf16_f32 v22, v76, v77
    v_cvt_pk_bf16_f32 v23, v78, v79
    v_permlane32_swap_b32 v16, v18
    v_permlane32_swap_b32 v17, v19
    buffer_store_dwordx4 v[16:19], v3, s[36:39], s50 offen
    v_permlane32_swap_b32 v20, v22
    v_permlane32_swap_b32 v21, v23
    buffer_store_dwordx4 v[20:23], v3, s[36:39], s50 offen offset:32
    s_endpgm
L_ort_59:
    s_cmp_eq_u32 s97, 0
    s_cbranch_scc1 L_ook_58
    s_sub_u32 s97, s97, 1
    s_mov_b32 s62, 0
    buffer_load_dwordx4 v[80:83], v2, s[32:35], s62 offen offset:0 sc1
    buffer_load_dwordx4 v[84:87], v2, s[32:35], s62 offen offset:2048 sc1
    s_mov_b32 s62, 4096
    buffer_load_dwordx4 v[88:91], v2, s[32:35], s62 offen offset:0 sc1
    buffer_load_dwordx4 v[92:95], v2, s[32:35], s62 offen offset:2048 sc1
    s_mov_b32 s62, 8192
    buffer_load_dwordx4 v[112:115], v2, s[32:35], s62 offen offset:0 sc1
    buffer_load_dwordx4 v[116:119], v2, s[32:35], s62 offen offset:2048 sc1
    s_mov_b32 s62, 12288
    buffer_load_dwordx4 v[120:123], v2, s[32:35], s62 offen offset:0 sc1
    buffer_load_dwordx4 v[124:127], v2, s[32:35], s62 offen offset:2048 sc1
    s_mov_b32 s62, 1024
    buffer_load_dwordx4 v[28:31], v2, s[32:35], s62 offen offset:0 sc1
    buffer_load_dwordx4 v[32:35], v2, s[32:35], s62 offen offset:2048 sc1
    s_mov_b32 s62, 5120
    buffer_load_dwordx4 v[36:39], v2, s[32:35], s62 offen offset:0 sc1
    buffer_load_dwordx4 v[40:43], v2, s[32:35], s62 offen offset:2048 sc1
    s_mov_b32 s62, 9216
    buffer_load_dwordx4 v[44:47], v2, s[32:35], s62 offen offset:0 sc1
    buffer_load_dwordx4 v[48:51], v2, s[32:35], s62 offen offset:2048 sc1
    s_mov_b32 s62, 13312
    buffer_load_dwordx4 v[52:55], v2, s[32:35], s62 offen offset:0 sc1
    buffer_load_dwordx4 v[56:59], v2, s[32:35], s62 offen offset:2048 sc1
    s_branch L_ochk_57
L_ort_62:
    s_cmp_eq_u32 s97, 0
    s_cbranch_scc1 L_ook_61
    s_sub_u32 s97, s97, 1
    s_mov_b32 s62, 4096
    buffer_load_dwordx4 v[88:91], v2, s[32:35], s62 offen offset:0 sc1
    buffer_load_dwordx4 v[92:95], v2, s[32:35], s62 offen offset:2048 sc1
    s_mov_b32 s62, 8192
    buffer_load_dwordx4 v[112:115], v2, s[32:35], s62 offen offset:0 sc1
    buffer_load_dwordx4 v[116:119], v2, s[32:35], s62 offen offset:2048 sc1
    s_mov_b32 s62, 12288
    buffer_load_dwordx4 v[120:123], v2, s[32:35], s62 offen offset:0 sc1
    buffer_load_dwordx4 v[124:127], v2, s[32:35], s62 offen offset:2048 sc1
    s_mov_b32 s62, 1024
    buffer_load_dwordx4 v[28:31], v2, s[32:35], s62 offen offset:0 sc1
    buffer_load_dwordx4 v[32:35], v2, s[32:35], s62 offen offset:2048 sc1
    s_mov_b32 s62, 5120
    buffer_load_dwordx4 v[36:39], v2, s[32:35], s62 offen offset:0 sc1
    buffer_load_dwordx4 v[40:43], v2, s[32:35], s62 offen offset:2048 sc1
    s_mov_b32 s62, 9216
    buffer_load_dwordx4 v[44:47], v2, s[32:35], s62 offen offset:0 sc1
    buffer_load_dwordx4 v[48:51], v2, s[32:35], s62 offen offset:2048 sc1
    s_mov_b32 s62, 13312
    buffer_load_dwordx4 v[52:55], v2, s[32:35], s62 offen offset:0 sc1
    buffer_load_dwordx4 v[56:59], v2, s[32:35], s62 offen offset:2048 sc1
    s_branch L_ochk_60
L_ort_65:
    s_cmp_eq_u32 s97, 0
    s_cbranch_scc1 L_ook_64
    s_sub_u32 s97, s97, 1
    s_mov_b32 s62, 8192
    buffer_load_dwordx4 v[112:115], v2, s[32:35], s62 offen offset:0 sc1
    buffer_load_dwordx4 v[116:119], v2, s[32:35], s62 offen offset:2048 sc1
    s_mov_b32 s62, 12288
    buffer_load_dwordx4 v[120:123], v2, s[32:35], s62 offen offset:0 sc1
    buffer_load_dwordx4 v[124:127], v2, s[32:35], s62 offen offset:2048 sc1
    s_mov_b32 s62, 1024
    buffer_load_dwordx4 v[28:31], v2, s[32:35], s62 offen offset:0 sc1
    buffer_load_dwordx4 v[32:35], v2, s[32:35], s62 offen offset:2048 sc1
    s_mov_b32 s62, 5120
    buffer_load_dwordx4 v[36:39], v2, s[32:35], s62 offen offset:0 sc1
    buffer_load_dwordx4 v[40:43], v2, s[32:35], s62 offen offset:2048 sc1
    s_mov_b32 s62, 9216
    buffer_load_dwordx4 v[44:47], v2, s[32:35], s62 offen offset:0 sc1
    buffer_load_dwordx4 v[48:51], v2, s[32:35], s62 offen offset:2048 sc1
    s_mov_b32 s62, 13312
    buffer_load_dwordx4 v[52:55], v2, s[32:35], s62 offen offset:0 sc1
    buffer_load_dwordx4 v[56:59], v2, s[32:35], s62 offen offset:2048 sc1
    s_branch L_ochk_63
L_ort_68:
    s_cmp_eq_u32 s97, 0
    s_cbranch_scc1 L_ook_67
    s_sub_u32 s97, s97, 1
    s_mov_b32 s62, 12288
    buffer_load_dwordx4 v[120:123], v2, s[32:35], s62 offen offset:0 sc1
    buffer_load_dwordx4 v[124:127], v2, s[32:35], s62 offen offset:2048 sc1
    s_mov_b32 s62, 1024
    buffer_load_dwordx4 v[28:31], v2, s[32:35], s62 offen offset:0 sc1
    buffer_load_dwordx4 v[32:35], v2, s[32:35], s62 offen offset:2048 sc1
    s_mov_b32 s62, 5120
    buffer_load_dwordx4 v[36:39], v2, s[32:35], s62 offen offset:0 sc1
    buffer_load_dwordx4 v[40:43], v2, s[32:35], s62 offen offset:2048 sc1
    s_mov_b32 s62, 9216
    buffer_load_dwordx4 v[44:47], v2, s[32:35], s62 offen offset:0 sc1
    buffer_load_dwordx4 v[48:51], v2, s[32:35], s62 offen offset:2048 sc1
    s_mov_b32 s62, 13312
    buffer_load_dwordx4 v[52:55], v2, s[32:35], s62 offen offset:0 sc1
    buffer_load_dwordx4 v[56:59], v2, s[32:35], s62 offen offset:2048 sc1
    s_branch L_ochk_66
L_ort_71:
    s_cmp_eq_u32 s97, 0
    s_cbranch_scc1 L_ook_70
    s_sub_u32 s97, s97, 1
    s_mov_b32 s62, 1024
    buffer_load_dwordx4 v[28:31], v2, s[32:35], s62 offen offset:0 sc1
    buffer_load_dwordx4 v[32:35], v2, s[32:35], s62 offen offset:2048 sc1
    s_mov_b32 s62, 5120
    buffer_load_dwordx4 v[36:39], v2, s[32:35], s62 offen offset:0 sc1
    buffer_load_dwordx4 v[40:43], v2, s[32:35], s62 offen offset:2048 sc1
    s_mov_b32 s62, 9216
    buffer_load_dwordx4 v[44:47], v2, s[32:35], s62 offen offset:0 sc1
    buffer_load_dwordx4 v[48:51], v2, s[32:35], s62 offen offset:2048 sc1
    s_mov_b32 s62, 13312
    buffer_load_dwordx4 v[52:55], v2, s[32:35], s62 offen offset:0 sc1
    buffer_load_dwordx4 v[56:59], v2, s[32:35], s62 offen offset:2048 sc1
    s_branch L_ochk_69
L_ort_74:
    s_cmp_eq_u32 s97, 0
    s_cbranch_scc1 L_ook_73
    s_sub_u32 s97, s97, 1
    s_mov_b32 s62, 5120
    buffer_load_dwordx4 v[36:39], v2, s[32:35], s62 offen offset:0 sc1
    buffer_load_dwordx4 v[40:43], v2, s[32:35], s62 offen offset:2048 sc1
    s_mov_b32 s62, 9216
    buffer_load_dwordx4 v[44:47], v2, s[32:35], s62 offen offset:0 sc1
    buffer_load_dwordx4 v[48:51], v2, s[32:35], s62 offen offset:2048 sc1
    s_mov_b32 s62, 13312
    buffer_load_dwordx4 v[52:55], v2, s[32:35], s62 offen offset:0 sc1
    buffer_load_dwordx4 v[56:59], v2, s[32:35], s62 offen offset:2048 sc1
    s_branch L_ochk_72
L_ort_77:
    s_cmp_eq_u32 s97, 0
    s_cbranch_scc1 L_ook_76
    s_sub_u32 s97, s97, 1
    s_mov_b32 s62, 9216
    buffer_load_dwordx4 v[44:47], v2, s[32:35], s62 offen offset:0 sc1
    buffer_load_dwordx4 v[48:51], v2, s[32:35], s62 offen offset:2048 sc1
    s_mov_b32 s62, 13312
    buffer_load_dwordx4 v[52:55], v2, s[32:35], s62 offen offset:0 sc1
    buffer_load_dwordx4 v[56:59], v2, s[32:35], s62 offen offset:2048 sc1
    s_branch L_ochk_75
L_ort_80:
    s_cmp_eq_u32 s97, 0
    s_cbranch_scc1 L_ook_79
    s_sub_u32 s97, s97, 1
    s_mov_b32 s62, 13312
    buffer_load_dwordx4 v[52:55], v2, s[32:35], s62 offen offset:0 sc1
    buffer_load_dwordx4 v[56:59], v2, s[32:35], s62 offen offset:2048 sc1
    s_branch L_ochk_78
L_compkv:
    v_lshl_add_u32 v60, v8, 6, v11
    v_add_u32 v60, 131072, v60
    v_lshl_add_u32 v12, v9, 11, v10
    v_lshl_add_u32 v61, v8, 5, v12
    v_add_u32 v61, 131072, v61
    v_lshlrev_b32 v12, 4, v2
    s_add_u32 s3, s31, 0
    s_and_b32 s3, s3, 7
    s_lshl_b32 s3, s3, 7
    s_add_u32 s3, s3, 159744
    v_add_u32 v128, s3, v12
    s_add_u32 s3, s31, 1
    s_and_b32 s3, s3, 7
    s_lshl_b32 s3, s3, 7
    s_add_u32 s3, s3, 159744
    v_add_u32 v129, s3, v12
    s_add_u32 s3, s31, 2
    s_and_b32 s3, s3, 7
    s_lshl_b32 s3, s3, 7
    s_add_u32 s3, s3, 159744
    v_add_u32 v130, s3, v12
    s_add_u32 s3, s31, 3
    s_and_b32 s3, s3, 7
    s_lshl_b32 s3, s3, 7
    s_add_u32 s3, s3, 159744
    v_add_u32 v131, s3, v12
    s_add_u32 s3, s31, 4
    s_and_b32 s3, s3, 7
    s_lshl_b32 s3, s3, 7
    s_add_u32 s3, s3, 159744
    v_add_u32 v132, s3, v12
    s_add_u32 s3, s31, 5
    s_and_b32 s3, s3, 7
    s_lshl_b32 s3, s3, 7
    s_add_u32 s3, s3, 159744
    v_add_u32 v133, s3, v12
    s_add_u32 s3, s31, 6
    s_and_b32 s3, s3, 7
    s_lshl_b32 s3, s3, 7
    s_add_u32 s3, s3, 159744
    v_add_u32 v134, s3, v12
    s_add_u32 s3, s31, 7
    s_and_b32 s3, s3, 7
    s_lshl_b32 s3, s3, 7
    s_add_u32 s3, s3, 159744
    v_add_u32 v135, s3, v12
    v_and_b32 v136, 31, v0
    v_lshlrev_b32 v136, 4, v136
    v_mul_u32_u24 v137, 1040, v2
    v_add_u32 v137, v137, v136
    v_lshl_add_u32 v138, v2, 8, v136
    v_mul_u32_u24 v139, 1040, v0
    v_mov_b32 v140, 0x3f803f80
    v_mov_b32 v141, 0x3f803f80
    v_mov_b32 v142, 0x3f803f80
    v_mov_b32 v143, 0x3f803f80
    s_mul_i32 s61, s58, 2080
    s_mov_b32 s63, 133120
    s_mov_b32 s44, s24
    s_mov_b32 s45, s25
    s_mov_b32 s46, 256
    s_mov_b32 s47, 0x20000
    s_barrier
    ds_read_b128 v[160:163], v52 offset:0
    ds_read_b64_tr_b16 v[192:193], v61 offset:0
    ds_read_b64_tr_b16 v[194:195], v61 offset:128
    ds_read_b128 v[164:167], v53 offset:0
    ds_read_b64_tr_b16 v[196:197], v61 offset:512
    ds_read_b64_tr_b16 v[198:199], v61 offset:640
    ds_read_b128 v[168:171], v54 offset:0
    ds_read_b64_tr_b16 v[200:201], v61 offset:1024
    ds_read_b64_tr_b16 v[202:203], v61 offset:1152
    ds_read_b128 v[172:175], v55 offset:0
    ds_read_b64_tr_b16 v[204:205], v61 offset:1536
    ds_read_b64_tr_b16 v[206:207], v61 offset:1664
    s_waitcnt lgkmcnt(0)
    s_barrier
    v_mfma_f32_32x32x16_bf16 v[80:95], v[192:195], v[160:163], 0
    ds_read_b128 v[176:179], v52 offset:16384
    ds_read_b64_tr_b16 v[208:209], v61 offset:4096
    ds_read_b64_tr_b16 v[210:211], v61 offset:4224
    ds_read_b128 v[180:183], v53 offset:16384
    ds_read_b64_tr_b16 v[212:213], v61 offset:4608
    ds_read_b64_tr_b16 v[214:215], v61 offset:4736
    v_mfma_f32_32x32x16_bf16 v[96:111], v[160:163], v[192:195], 0
    ds_read_b128 v[184:187], v54 offset:16384
    ds_read_b64_tr_b16 v[216:217], v61 offset:5120
    ds_read_b64_tr_b16 v[218:219], v61 offset:5248
    ds_read_b128 v[188:191], v55 offset:16384
    ds_read_b64_tr_b16 v[220:221], v61 offset:5632
    ds_read_b64_tr_b16 v[222:223], v61 offset:5760
    v_mfma_f32_32x32x16_bf16 v[80:95], v[196:199], v[164:167], v[80:95]
    v_mfma_f32_32x32x16_bf16 v[96:111], v[164:167], v[196:199], v[96:111]
    v_mfma_f32_32x32x16_bf16 v[80:95], v[200:203], v[168:171], v[80:95]
    v_mfma_f32_32x32x16_bf16 v[96:111], v[168:171], v[200:203], v[96:111]
    v_mfma_f32_32x32x16_bf16 v[80:95], v[204:207], v[172:175], v[80:95]
    v_mfma_f32_32x32x16_bf16 v[96:111], v[172:175], v[204:207], v[96:111]
    s_waitcnt lgkmcnt(0)
    s_barrier
    v_mfma_f32_32x32x16_bf16 v[80:95], v[208:211], v[176:179], v[80:95]
    ds_read_b128 v[160:163], v52 offset:32768
    ds_read_b64_tr_b16 v[192:193], v61 offset:8192
    ds_read_b64_tr_b16 v[194:195], v61 offset:8320
    ds_read_b128 v[164:167], v53 offset:32768
    ds_read_b64_tr_b16 v[196:197], v61 offset:8704
    ds_read_b64_tr_b16 v[198:199], v61 offset:8832
    v_mfma_f32_32x32x16_bf16 v[96:111], v[176:179], v[208:211], v[96:111]
    ds_read_b128 v[168:171], v54 offset:32768
    ds_read_b64_tr_b16 v[200:201], v61 offset:9216
    ds_read_b64_tr_b16 v[202:203], v61 offset:9344
    ds_read_b128 v[172:175], v55 offset:32768
    ds_read_b64_tr_b16 v[204:205], v61 offset:9728
    ds_read_b64_tr_b16 v[206:207], v61 offset:9856
    v_mfma_f32_32x32x16_bf16 v[80:95], v[212:215], v[180:183], v[80:95]
    v_mfma_f32_32x32x16_bf16 v[96:111], v[180:183], v[212:215], v[96:111]
    v_mfma_f32_32x32x16_bf16 v[80:95], v[216:219], v[184:187], v[80:95]
    v_mfma_f32_32x32x16_bf16 v[96:111], v[184:187], v[216:219], v[96:111]
    v_mfma_f32_32x32x16_bf16 v[80:95], v[220:223], v[188:191], v[80:95]
    v_mfma_f32_32x32x16_bf16 v[96:111], v[188:191], v[220:223], v[96:111]
    s_waitcnt lgkmcnt(0)
    s_barrier
    v_mfma_f32_32x32x16_bf16 v[80:95], v[192:195], v[160:163], v[80:95]
    ds_read_b128 v[176:179], v52 offset:49152
    ds_read_b64_tr_b16 v[208:209], v61 offset:12288
    ds_read_b64_tr_b16 v[210:211], v61 offset:12416
    ds_read_b128 v[180:183], v53 offset:49152
    ds_read_b64_tr_b16 v[212:213], v61 offset:12800
    ds_read_b64_tr_b16 v[214:215], v61 offset:12928
    v_mfma_f32_32x32x16_bf16 v[96:111], v[160:163], v[192:195], v[96:111]
    ds_read_b128 v[184:187], v54 offset:49152
    ds_read_b64_tr_b16 v[216:217], v61 offset:13312
    ds_read_b64_tr_b16 v[218:219], v61 offset:13440
    ds_read_b128 v[188:191], v55 offset:49152
    ds_read_b64_tr_b16 v[220:221], v61 offset:13824
    ds_read_b64_tr_b16 v[222:223], v61 offset:13952
    v_mfma_f32_32x32x16_bf16 v[80:95], v[196:199], v[164:167], v[80:95]
    v_mfma_f32_32x32x16_bf16 v[96:111], v[164:167], v[196:199], v[96:111]
    v_mfma_f32_32x32x16_bf16 v[80:95], v[200:203], v[168:171], v[80:95]
    v_mfma_f32_32x32x16_bf16 v[96:111], v[168:171], v[200:203], v[96:111]
    v_mfma_f32_32x32x16_bf16 v[80:95], v[204:207], v[172:175], v[80:95]
    v_mfma_f32_32x32x16_bf16 v[96:111], v[172:175], v[204:207], v[96:111]
    s_waitcnt lgkmcnt(0)
    s_barrier
    v_mfma_f32_32x32x16_bf16 v[80:95], v[208:211], v[176:179], v[80:95]
    ds_read_b128 v[160:163], v56 offset:0
    ds_read_b64_tr_b16 v[192:193], v61 offset:16384
    ds_read_b64_tr_b16 v[194:195], v61 offset:16512
    ds_read_b128 v[164:167], v57 offset:0
    ds_read_b64_tr_b16 v[196:197], v61 offset:16896
    ds_read_b64_tr_b16 v[198:199], v61 offset:17024
    v_mfma_f32_32x32x16_bf16 v[96:111], v[176:179], v[208:211], v[96:111]
    ds_read_b128 v[168:171], v58 offset:0
    ds_read_b64_tr_b16 v[200:201], v61 offset:17408
    ds_read_b64_tr_b16 v[202:203], v61 offset:17536
    ds_read_b128 v[172:175], v59 offset:0
    ds_read_b64_tr_b16 v[204:205], v61 offset:17920
    ds_read_b64_tr_b16 v[206:207], v61 offset:18048
    v_mfma_f32_32x32x16_bf16 v[80:95], v[212:215], v[180:183], v[80:95]
    v_mfma_f32_32x32x16_bf16 v[96:111], v[180:183], v[212:215], v[96:111]
    v_mfma_f32_32x32x16_bf16 v[80:95], v[216:219], v[184:187], v[80:95]
    v_mfma_f32_32x32x16_bf16 v[96:111], v[184:187], v[216:219], v[96:111]
    v_mfma_f32_32x32x16_bf16 v[80:95], v[220:223], v[188:191], v[80:95]
    v_mfma_f32_32x32x16_bf16 v[96:111], v[188:191], v[220:223], v[96:111]
    s_waitcnt lgkmcnt(0)
    s_barrier
    v_mfma_f32_32x32x16_bf16 v[80:95], v[192:195], v[160:163], v[80:95]
    ds_read_b128 v[176:179], v56 offset:16384
    ds_read_b64_tr_b16 v[208:209], v61 offset:20480
    ds_read_b64_tr_b16 v[210:211], v61 offset:20608
    ds_read_b128 v[180:183], v57 offset:16384
    ds_read_b64_tr_b16 v[212:213], v61 offset:20992
    ds_read_b64_tr_b16 v[214:215], v61 offset:21120
    v_mfma_f32_32x32x16_bf16 v[96:111], v[160:163], v[192:195], v[96:111]
    ds_read_b128 v[184:187], v58 offset:16384
    ds_read_b64_tr_b16 v[216:217], v61 offset:21504
    ds_read_b64_tr_b16 v[218:219], v61 offset:21632
    ds_read_b128 v[188:191], v59 offset:16384
    ds_read_b64_tr_b16 v[220:221], v61 offset:22016
    ds_read_b64_tr_b16 v[222:223], v61 offset:22144
    v_mfma_f32_32x32x16_bf16 v[80:95], v[196:199], v[164:167], v[80:95]
    v_mfma_f32_32x32x16_bf16 v[96:111], v[164:167], v[196:199], v[96:111]
    v_mfma_f32_32x32x16_bf16 v[80:95], v[200:203], v[168:171], v[80:95]
    v_mfma_f32_32x32x16_bf16 v[96:111], v[168:171], v[200:203], v[96:111]
    v_mfma_f32_32x32x16_bf16 v[80:95], v[204:207], v[172:175], v[80:95]
    v_mfma_f32_32x32x16_bf16 v[96:111], v[172:175], v[204:207], v[96:111]
    s_waitcnt lgkmcnt(0)
    s_barrier
    v_mfma_f32_32x32x16_bf16 v[80:95], v[208:211], v[176:179], v[80:95]
    ds_read_b128 v[160:163], v56 offset:32768
    ds_read_b64_tr_b16 v[192:193], v61 offset:24576
    ds_read_b64_tr_b16 v[194:195], v61 offset:24704
    ds_read_b128 v[164:167], v57 offset:32768
    ds_read_b64_tr_b16 v[196:197], v61 offset:25088
    ds_read_b64_tr_b16 v[198:199], v61 offset:25216
    v_mfma_f32_32x32x16_bf16 v[96:111], v[176:179], v[208:211], v[96:111]
    ds_read_b128 v[168:171], v58 offset:32768
    ds_read_b64_tr_b16 v[200:201], v61 offset:25600
    ds_read_b64_tr_b16 v[202:203], v61 offset:25728
    ds_read_b128 v[172:175], v59 offset:32768
    ds_read_b64_tr_b16 v[204:205], v61 offset:26112
    ds_read_b64_tr_b16 v[206:207], v61 offset:26240
    v_mfma_f32_32x32x16_bf16 v[80:95], v[212:215], v[180:183], v[80:95]
    v_mfma_f32_32x32x16_bf16 v[96:111], v[180:183], v[212:215], v[96:111]
    v_mfma_f32_32x32x16_bf16 v[80:95], v[216:219], v[184:187], v[80:95]
    v_mfma_f32_32x32x16_bf16 v[96:111], v[184:187], v[216:219], v[96:111]
    v_mfma_f32_32x32x16_bf16 v[80:95], v[220:223], v[188:191], v[80:95]
    v_mfma_f32_32x32x16_bf16 v[96:111], v[188:191], v[220:223], v[96:111]
    s_waitcnt lgkmcnt(0)
    s_barrier
    v_mfma_f32_32x32x16_bf16 v[80:95], v[192:195], v[160:163], v[80:95]
    ds_read_b128 v[176:179], v56 offset:49152
    ds_read_b64_tr_b16 v[208:209], v61 offset:0
    ds_read_b64_tr_b16 v[210:211], v61 offset:128
    ds_read_b128 v[180:183], v57 offset:49152
    ds_read_b64_tr_b16 v[212:213], v61 offset:512
    ds_read_b64_tr_b16 v[214:215], v61 offset:640
    v_mfma_f32_32x32x16_bf16 v[96:111], v[160:163], v[192:195], v[96:111]
    ds_read_b128 v[184:187], v58 offset:49152
    ds_read_b64_tr_b16 v[216:217], v61 offset:1024
    ds_read_b64_tr_b16 v[218:219], v61 offset:1152
    ds_read_b128 v[188:191], v59 offset:49152
    ds_read_b64_tr_b16 v[220:221], v61 offset:1536
    ds_read_b64_tr_b16 v[222:223], v61 offset:1664
    v_mfma_f32_32x32x16_bf16 v[80:95], v[196:199], v[164:167], v[80:95]
    v_mfma_f32_32x32x16_bf16 v[96:111], v[164:167], v[196:199], v[96:111]
    v_mfma_f32_32x32x16_bf16 v[80:95], v[200:203], v[168:171], v[80:95]
    v_mfma_f32_32x32x16_bf16 v[96:111], v[168:171], v[200:203], v[96:111]
    v_mfma_f32_32x32x16_bf16 v[80:95], v[204:207], v[172:175], v[80:95]
    v_mfma_f32_32x32x16_bf16 v[96:111], v[172:175], v[204:207], v[96:111]
    s_waitcnt lgkmcnt(9)
    v_mfma_f32_32x32x16_bf16 v[80:95], v[208:211], v[176:179], v[80:95]
    v_mfma_f32_32x32x16_bf16 v[96:111], v[176:179], v[208:211], v[96:111]
    s_waitcnt lgkmcnt(6)
    v_mfma_f32_32x32x16_bf16 v[80:95], v[212:215], v[180:183], v[80:95]
    v_mfma_f32_32x32x16_bf16 v[96:111], v[180:183], v[212:215], v[96:111]
    s_waitcnt lgkmcnt(3)
    v_mfma_f32_32x32x16_bf16 v[80:95], v[216:219], v[184:187], v[80:95]
    v_mfma_f32_32x32x16_bf16 v[96:111], v[184:187], v[216:219], v[96:111]
    s_waitcnt lgkmcnt(0)
    v_mfma_f32_32x32x16_bf16 v[80:95], v[220:223], v[188:191], v[80:95]
    v_mfma_f32_32x32x16_bf16 v[96:111], v[188:191], v[220:223], v[96:111]
    s_mov_b64 exec, 3
    buffer_store_dwordx4 v[140:143], v139, s[32:35], s61 offen offset:1024 sc1
    s_mov_b64 exec, -1
    s_nop 7
    v_cvt_pk_bf16_f32 v144, v80, v81
    v_cvt_pk_bf16_f32 v145, v82, v83
    v_cvt_pk_bf16_f32 v146, v84, v85
    v_cvt_pk_bf16_f32 v147, v86, v87
    buffer_store_dwordx4 v[144:147], v137, s[32:35], s61 offen sc1
    v_cvt_pk_bf16_f32 v148, v96, v97
    v_cvt_pk_bf16_f32 v149, v98, v99
    v_cvt_pk_bf16_f32 v150, v100, v101
    v_cvt_pk_bf16_f32 v151, v102, v103
    v_cvt_pk_bf16_f32 v152, v104, v105
    v_cvt_pk_bf16_f32 v153, v106, v107
    v_cvt_pk_bf16_f32 v154, v108, v109
    v_cvt_pk_bf16_f32 v155, v110, v111
    v_permlane32_swap_b32 v148, v150
    v_permlane32_swap_b32 v149, v151
    v_permlane32_swap_b32 v152, v154
    v_permlane32_swap_b32 v153, v155
    s_mov_b32 exec_lo, 0xffff0000
    s_mov_b32 exec_hi, 0xffff0000
    buffer_store_dwordx4 v[148:151], v138, s[32:35], s61 offen offset:256 sc1
    buffer_store_dwordx4 v[152:155], v138, s[32:35], s61 offen offset:1296 sc1
    s_cmp_eq_u32 s58, 0
    s_cbranch_scc0 L_nodup_81
    buffer_store_dwordx4 v[148:151], v138, s[32:35], s63 offen offset:256 sc1
    s_mov_b32 exec_lo, -1
    s_mov_b32 exec_hi, 0
    buffer_store_dwordx4 v[144:147], v137, s[32:35], s63 offen sc1
L_nodup_81:
    s_mov_b64 exec, -1
    s_barrier
    ds_read_b128 v[160:163], v52 offset:0
    ds_read_b64_tr_b16 v[192:193], v60 offset:4096
    ds_read_b64_tr_b16 v[194:195], v60 offset:4352
    ds_read_b128 v[196:199], v128 offset:0
    ds_read_b128 v[164:167], v53 offset:0
    ds_read_b64_tr_b16 v[200:201], v60 offset:5120
    ds_read_b64_tr_b16 v[202:203], v60 offset:5376
    ds_read_b128 v[204:207], v128 offset:32
    s_waitcnt lgkmcnt(5)
    v_mfma_f32_32x32x16_bf16 v[64:79], v[192:195], v[160:163], 0
    ds_read_b128 v[176:179], v54 offset:0
    ds_read_b64_tr_b16 v[208:209], v60 offset:6144
    ds_read_b64_tr_b16 v[210:211], v60 offset:6400
    ds_read_b128 v[212:215], v128 offset:64
    s_waitcnt lgkmcnt(8)
    v_mfma_f32_32x32x16_bf16 v[112:127], v[196:199], v[160:163], 0
    ds_read_b128 v[180:183], v55 offset:0
    ds_read_b64_tr_b16 v[216:217], v60 offset:7168
    ds_read_b64_tr_b16 v[218:219], v60 offset:7424
    ds_read_b128 v[220:223], v128 offset:96
    s_waitcnt lgkmcnt(9)
    v_mfma_f32_32x32x16_bf16 v[64:79], v[200:203], v[164:167], v[64:79]
    s_waitcnt lgkmcnt(8)
    v_mfma_f32_32x32x16_bf16 v[112:127], v[204:207], v[164:167], v[112:127]
    s_waitcnt lgkmcnt(0)
    s_barrier
    v_mfma_f32_32x32x16_bf16 v[64:79], v[208:211], v[176:179], v[64:79]
    ds_read_b128 v[160:163], v52 offset:16384
    ds_read_b64_tr_b16 v[192:193], v60 offset:8192
    ds_read_b64_tr_b16 v[194:195], v60 offset:8448
    ds_read_b128 v[196:199], v129 offset:0
    v_mfma_f32_32x32x16_bf16 v[112:127], v[212:215], v[176:179], v[112:127]
    ds_read_b128 v[164:167], v53 offset:16384
    ds_read_b64_tr_b16 v[200:201], v60 offset:9216
    ds_read_b64_tr_b16 v[202:203], v60 offset:9472
    ds_read_b128 v[204:207], v129 offset:32
    v_mfma_f32_32x32x16_bf16 v[64:79], v[216:219], v[180:183], v[64:79]
    v_mfma_f32_32x32x16_bf16 v[112:127], v[220:223], v[180:183], v[112:127]
    s_waitcnt lgkmcnt(5)
    v_mfma_f32_32x32x16_bf16 v[64:79], v[192:195], v[160:163], v[64:79]
    ds_read_b128 v[176:179], v54 offset:16384
    ds_read_b64_tr_b16 v[208:209], v60 offset:10240
    ds_read_b64_tr_b16 v[210:211], v60 offset:10496
    ds_read_b128 v[212:215], v129 offset:64
    s_waitcnt lgkmcnt(8)
    v_mfma_f32_32x32x16_bf16 v[112:127], v[196:199], v[160:163], v[112:127]
    ds_read_b128 v[180:183], v55 offset:16384
    ds_read_b64_tr_b16 v[216:217], v60 offset:11264
    ds_read_b64_tr_b16 v[218:219], v60 offset:11520
    ds_read_b128 v[220:223], v129 offset:96
    s_waitcnt lgkmcnt(9)
    v_mfma_f32_32x32x16_bf16 v[64:79], v[200:203], v[164:167], v[64:79]
    s_waitcnt lgkmcnt(8)
    v_mfma_f32_32x32x16_bf16 v[112:127], v[204:207], v[164:167], v[112:127]
    s_waitcnt lgkmcnt(0)
    s_waitcnt vmcnt(0)
    s_barrier
    s_cmp_eq_u32 s48, 0
    s_cbranch_scc0 L_nopub_82
    s_mov_b64 exec, 1
    v_add_u32 v63, 1, v63
    s_lshl_b32 s3, s29, 8
    s_add_u32 s3, s3, 393216
    buffer_store_dword v63, v238, s[32:35], s3 offen sc1
    s_lshl_b32 s3, s29, 2
    buffer_store_dword v241, v238, s[44:47], s3 offen sc1
    s_mov_b64 exec, -1
L_nopub_82:
    v_mfma_f32_32x32x16_bf16 v[64:79], v[208:211], v[176:179], v[64:79]
    ds_read_b128 v[160:163], v52 offset:32768
    ds_read_b64_tr_b16 v[192:193], v60 offset:12288
    ds_read_b64_tr_b16 v[194:195], v60 offset:12544
    ds_read_b128 v[196:199], v130 offset:0
    v_mfma_f32_32x32x16_bf16 v[112:127], v[212:215], v[176:179], v[112:127]
    ds_read_b128 v[164:167], v53 offset:32768
    ds_read_b64_tr_b16 v[200:201], v60 offset:13312
    ds_read_b64_tr_b16 v[202:203], v60 offset:13568
    ds_read_b128 v[204:207], v130 offset:32
    v_mfma_f32_32x32x16_bf16 v[64:79], v[216:219], v[180:183], v[64:79]
    v_mfma_f32_32x32x16_bf16 v[112:127], v[220:223], v[180:183], v[112:127]
    s_waitcnt lgkmcnt(5)
    v_mfma_f32_32x32x16_bf16 v[64:79], v[192:195], v[160:163], v[64:79]
    ds_read_b128 v[176:179], v54 offset:32768
    ds_read_b64_tr_b16 v[208:209], v60 offset:14336
    ds_read_b64_tr_b16 v[210:211], v60 offset:14592
    ds_read_b128 v[212:215], v130 offset:64
    s_waitcnt lgkmcnt(8)
    v_mfma_f32_32x32x16_bf16 v[112:127], v[196:199], v[160:163], v[112:127]
    ds_read_b128 v[180:183], v55 offset:32768
    ds_read_b64_tr_b16 v[216:217], v60 offset:15360
    ds_read_b64_tr_b16 v[218:219], v60 offset:15616
    ds_read_b128 v[220:223], v130 offset:96
    s_waitcnt lgkmcnt(9)
    v_mfma_f32_32x32x16_bf16 v[64:79], v[200:203], v[164:167], v[64:79]
    s_waitcnt lgkmcnt(8)
    v_mfma_f32_32x32x16_bf16 v[112:127], v[204:207], v[164:167], v[112:127]
    s_waitcnt lgkmcnt(0)
    s_barrier
    v_mfma_f32_32x32x16_bf16 v[64:79], v[208:211], v[176:179], v[64:79]
    ds_read_b128 v[160:163], v52 offset:49152
    ds_read_b64_tr_b16 v[192:193], v60 offset:16384
    ds_read_b64_tr_b16 v[194:195], v60 offset:16640
    ds_read_b128 v[196:199], v131 offset:0
    v_mfma_f32_32x32x16_bf16 v[112:127], v[212:215], v[176:179], v[112:127]
    ds_read_b128 v[164:167], v53 offset:49152
    ds_read_b64_tr_b16 v[200:201], v60 offset:17408
    ds_read_b64_tr_b16 v[202:203], v60 offset:17664
    ds_read_b128 v[204:207], v131 offset:32
    v_mfma_f32_32x32x16_bf16 v[64:79], v[216:219], v[180:183], v[64:79]
    v_mfma_f32_32x32x16_bf16 v[112:127], v[220:223], v[180:183], v[112:127]
    s_waitcnt lgkmcnt(5)
    v_mfma_f32_32x32x16_bf16 v[64:79], v[192:195], v[160:163], v[64:79]
    ds_read_b128 v[176:179], v54 offset:49152
    ds_read_b64_tr_b16 v[208:209], v60 offset:18432
    ds_read_b64_tr_b16 v[210:211], v60 offset:18688
    ds_read_b128 v[212:215], v131 offset:64
    s_waitcnt lgkmcnt(8)
    v_mfma_f32_32x32x16_bf16 v[112:127], v[196:199], v[160:163], v[112:127]
    ds_read_b128 v[180:183], v55 offset:49152
    ds_read_b64_tr_b16 v[216:217], v60 offset:19456
    ds_read_b64_tr_b16 v[218:219], v60 offset:19712
    ds_read_b128 v[220:223], v131 offset:96
    s_waitcnt lgkmcnt(9)
    v_mfma_f32_32x32x16_bf16 v[64:79], v[200:203], v[164:167], v[64:79]
    s_waitcnt lgkmcnt(8)
    v_mfma_f32_32x32x16_bf16 v[112:127], v[204:207], v[164:167], v[112:127]
    s_waitcnt lgkmcnt(0)
    s_barrier
    v_mfma_f32_32x32x16_bf16 v[64:79], v[208:211], v[176:179], v[64:79]
    ds_read_b128 v[160:163], v56 offset:0
    ds_read_b64_tr_b16 v[192:193], v60 offset:20480
    ds_read_b64_tr_b16 v[194:195], v60 offset:20736
    ds_read_b128 v[196:199], v132 offset:0
    v_mfma_f32_32x32x16_bf16 v[112:127], v[212:215], v[176:179], v[112:127]
    ds_read_b128 v[164:167], v57 offset:0
    ds_read_b64_tr_b16 v[200:201], v60 offset:21504
    ds_read_b64_tr_b16 v[202:203], v60 offset:21760
    ds_read_b128 v[204:207], v132 offset:32
    v_mfma_f32_32x32x16_bf16 v[64:79], v[216:219], v[180:183], v[64:79]
    v_mfma_f32_32x32x16_bf16 v[112:127], v[220:223], v[180:183], v[112:127]
    s_waitcnt lgkmcnt(5)
    v_mfma_f32_32x32x16_bf16 v[64:79], v[192:195], v[160:163], v[64:79]
    ds_read_b128 v[176:179], v58 offset:0
    ds_read_b64_tr_b16 v[208:209], v60 offset:22528
    ds_read_b64_tr_b16 v[210:211], v60 offset:22784
    ds_read_b128 v[212:215], v132 offset:64
    s_waitcnt lgkmcnt(8)
    v_mfma_f32_32x32x16_bf16 v[112:127], v[196:199], v[160:163], v[112:127]
    ds_read_b128 v[180:183], v59 offset:0
    ds_read_b64_tr_b16 v[216:217], v60 offset:23552
    ds_read_b64_tr_b16 v[218:219], v60 offset:23808
    ds_read_b128 v[220:223], v132 offset:96
    s_waitcnt lgkmcnt(9)
    v_mfma_f32_32x32x16_bf16 v[64:79], v[200:203], v[164:167], v[64:79]
    s_waitcnt lgkmcnt(8)
    v_mfma_f32_32x32x16_bf16 v[112:127], v[204:207], v[164:167], v[112:127]
    s_waitcnt lgkmcnt(0)
    s_barrier
    v_mfma_f32_32x32x16_bf16 v[64:79], v[208:211], v[176:179], v[64:79]
    ds_read_b128 v[160:163], v56 offset:16384
    ds_read_b64_tr_b16 v[192:193], v60 offset:24576
    ds_read_b64_tr_b16 v[194:195], v60 offset:24832
    ds_read_b128 v[196:199], v133 offset:0
    v_mfma_f32_32x32x16_bf16 v[112:127], v[212:215], v[176:179], v[112:127]
    ds_read_b128 v[164:167], v57 offset:16384
    ds_read_b64_tr_b16 v[200:201], v60 offset:25600
    ds_read_b64_tr_b16 v[202:203], v60 offset:25856
    ds_read_b128 v[204:207], v133 offset:32
    v_mfma_f32_32x32x16_bf16 v[64:79], v[216:219], v[180:183], v[64:79]
    v_mfma_f32_32x32x16_bf16 v[112:127], v[220:223], v[180:183], v[112:127]
    s_waitcnt lgkmcnt(5)
    v_mfma_f32_32x32x16_bf16 v[64:79], v[192:195], v[160:163], v[64:79]
    ds_read_b128 v[176:179], v58 offset:16384
    ds_read_b64_tr_b16 v[208:209], v60 offset:26624
    ds_read_b64_tr_b16 v[210:211], v60 offset:26880
    ds_read_b128 v[212:215], v133 offset:64
    s_waitcnt lgkmcnt(8)
    v_mfma_f32_32x32x16_bf16 v[112:127], v[196:199], v[160:163], v[112:127]
    ds_read_b128 v[180:183], v59 offset:16384
    ds_read_b64_tr_b16 v[216:217], v60 offset:27648
    ds_read_b64_tr_b16 v[218:219], v60 offset:27904
    ds_read_b128 v[220:223], v133 offset:96
    s_waitcnt lgkmcnt(9)
    v_mfma_f32_32x32x16_bf16 v[64:79], v[200:203], v[164:167], v[64:79]
    s_waitcnt lgkmcnt(8)
    v_mfma_f32_32x32x16_bf16 v[112:127], v[204:207], v[164:167], v[112:127]
    s_waitcnt lgkmcnt(0)
    s_barrier
    v_mfma_f32_32x32x16_bf16 v[64:79], v[208:211], v[176:179], v[64:79]
    ds_read_b128 v[160:163], v56 offset:32768
    ds_read_b64_tr_b16 v[192:193], v60 offset:0
    ds_read_b64_tr_b16 v[194:195], v60 offset:256
    ds_read_b128 v[196:199], v134 offset:0
    v_mfma_f32_32x32x16_bf16 v[112:127], v[212:215], v[176:179], v[112:127]
    ds_read_b128 v[164:167], v57 offset:32768
    ds_read_b64_tr_b16 v[200:201], v60 offset:1024
    ds_read_b64_tr_b16 v[202:203], v60 offset:1280
    ds_read_b128 v[204:207], v134 offset:32
    v_mfma_f32_32x32x16_bf16 v[64:79], v[216:219], v[180:183], v[64:79]
    v_mfma_f32_32x32x16_bf16 v[112:127], v[220:223], v[180:183], v[112:127]
    s_waitcnt lgkmcnt(5)
    v_mfma_f32_32x32x16_bf16 v[64:79], v[192:195], v[160:163], v[64:79]
    ds_read_b128 v[176:179], v58 offset:32768
    ds_read_b64_tr_b16 v[208:209], v60 offset:2048
    ds_read_b64_tr_b16 v[210:211], v60 offset:2304
    ds_read_b128 v[212:215], v134 offset:64
    s_waitcnt lgkmcnt(8)
    v_mfma_f32_32x32x16_bf16 v[112:127], v[196:199], v[160:163], v[112:127]
    ds_read_b128 v[180:183], v59 offset:32768
    ds_read_b64_tr_b16 v[216:217], v60 offset:3072
    ds_read_b64_tr_b16 v[218:219], v60 offset:3328
    ds_read_b128 v[220:223], v134 offset:96
    s_waitcnt lgkmcnt(9)
    v_mfma_f32_32x32x16_bf16 v[64:79], v[200:203], v[164:167], v[64:79]
    s_waitcnt lgkmcnt(8)
    v_mfma_f32_32x32x16_bf16 v[112:127], v[204:207], v[164:167], v[112:127]
    s_waitcnt lgkmcnt(0)
    s_barrier
    v_mfma_f32_32x32x16_bf16 v[64:79], v[208:211], v[176:179], v[64:79]
    ds_read_b128 v[160:163], v56 offset:49152
    ds_read_b64_tr_b16 v[192:193], v60 offset:4096
    ds_read_b64_tr_b16 v[194:195], v60 offset:4352
    ds_read_b128 v[196:199], v135 offset:0
    v_mfma_f32_32x32x16_bf16 v[112:127], v[212:215], v[176:179], v[112:127]
    ds_read_b128 v[164:167], v57 offset:49152
    ds_read_b64_tr_b16 v[200:201], v60 offset:5120
    ds_read_b64_tr_b16 v[202:203], v60 offset:5376
    ds_read_b128 v[204:207], v135 offset:32
    v_mfma_f32_32x32x16_bf16 v[64:79], v[216:219], v[180:183], v[64:79]
    v_mfma_f32_32x32x16_bf16 v[112:127], v[220:223], v[180:183], v[112:127]
    s_waitcnt lgkmcnt(5)
    v_mfma_f32_32x32x16_bf16 v[64:79], v[192:195], v[160:163], v[64:79]
    ds_read_b128 v[176:179], v58 offset:49152
    ds_read_b64_tr_b16 v[208:209], v60 offset:6144
    ds_read_b64_tr_b16 v[210:211], v60 offset:6400
    ds_read_b128 v[212:215], v135 offset:64
    s_waitcnt lgkmcnt(8)
    v_mfma_f32_32x32x16_bf16 v[112:127], v[196:199], v[160:163], v[112:127]
    ds_read_b128 v[180:183], v59 offset:49152
    ds_read_b64_tr_b16 v[216:217], v60 offset:7168
    ds_read_b64_tr_b16 v[218:219], v60 offset:7424
    ds_read_b128 v[220:223], v135 offset:96
    s_waitcnt lgkmcnt(9)
    v_mfma_f32_32x32x16_bf16 v[64:79], v[200:203], v[164:167], v[64:79]
    s_waitcnt lgkmcnt(8)
    v_mfma_f32_32x32x16_bf16 v[112:127], v[204:207], v[164:167], v[112:127]
    s_waitcnt lgkmcnt(0)
    s_barrier
    v_mfma_f32_32x32x16_bf16 v[64:79], v[208:211], v[176:179], v[64:79]
    v_mfma_f32_32x32x16_bf16 v[112:127], v[212:215], v[176:179], v[112:127]
    v_mfma_f32_32x32x16_bf16 v[64:79], v[216:219], v[180:183], v[64:79]
    v_mfma_f32_32x32x16_bf16 v[112:127], v[220:223], v[180:183], v[112:127]
    s_nop 10
    v_pk_mul_f32 v[64:65], v[64:65], s[54:55]
    v_pk_mul_f32 v[66:67], v[66:67], s[54:55]
    v_pk_mul_f32 v[68:69], v[68:69], s[54:55]
    v_pk_mul_f32 v[70:71], v[70:71], s[54:55]
    v_cvt_pk_bf16_f32 v4, v64, v65
    v_cvt_pk_bf16_f32 v5, v66, v67
    v_cvt_pk_bf16_f32 v6, v68, v69
    v_cvt_pk_bf16_f32 v7, v70, v71
    ds_write_b128 v243, v[4:7] offset:0
    v_pk_mul_f32 v[72:73], v[72:73], s[54:55]
    v_pk_mul_f32 v[74:75], v[74:75], s[54:55]
    v_pk_mul_f32 v[76:77], v[76:77], s[54:55]
    v_pk_mul_f32 v[78:79], v[78:79], s[54:55]
    v_cvt_pk_bf16_f32 v8, v72, v73
    v_cvt_pk_bf16_f32 v9, v74, v75
    v_cvt_pk_bf16_f32 v10, v76, v77
    v_cvt_pk_bf16_f32 v11, v78, v79
    ds_write_b128 v243, v[8:11] offset:1024
    s_waitcnt lgkmcnt(0)
    ds_add_u32 v240, v241 offset:24
    s_mov_b32 s54, 0xbfb8aa3b
    s_mov_b32 s55, 0xbfb8aa3b
    s_mov_b32 s62, 1.0
    s_mov_b32 s63, 1.0
    s_setprio 3
    s_branch L_g
L_exit:
    s_endpgm
.section .rodata,"a"
.p2align 6
.amdhsa_kernel gated_mix__grouped_kv_mqa__dense_activation_silu__prompt_kernel
  .amdhsa_next_free_vgpr 256
  .amdhsa_next_free_sgpr 102
  .amdhsa_accum_offset 256
  .amdhsa_group_segment_fixed_size 0
  .amdhsa_kernarg_size 96
  .amdhsa_user_sgpr_count 2
  .amdhsa_user_sgpr_kernarg_segment_ptr 1
  .amdhsa_system_sgpr_workgroup_id_x 1
.end_amdhsa_kernel
```
